```python
import torch

def _softmax(x, axis=-1):
    return torch.softmax(x, dim=axis)
def _gelu(x):
    return torch.nn.functional.gelu(x, approximate="tanh")
def _silu(x):
    return torch.nn.functional.silu(x)
def _sigmoid(x):
    return torch.sigmoid(x)
def _layernorm(x, axis=-1, eps=1e-5):
    m = x.mean(dim=axis, keepdim=True)
    v = x.var(dim=axis, keepdim=True, unbiased=False)
    return (x - m) / torch.sqrt(v + eps)
def _scatter_add(tgt, idx, src, axis=0):
    return tgt.clone().index_add_(axis, idx, src)
def _segment_sum(src, seg, n):
    out = torch.zeros((n,) + src.shape[1:], dtype=src.dtype)
    return out.index_add_(0, seg, src)
def _pad(x, pw):
    flat = tuple(v for pair in reversed(pw) for v in pair)
    return torch.nn.functional.pad(x, flat)

kernel_name = 'recurrent_scan__gqa_block_cached__dense_activation_relu__decode'

def setup_inputs():

    _w = (lambda a: (lambda t: t.to(torch.bfloat16) if t.is_floating_point() else t)(torch.as_tensor(a)))
    def _A_setup():
        B, Sq, D = 1, 1, 512
        Hq, Hkv, Sk, Dh = 32, 8, 65536, 128
        assert Hq % Hkv == 0, (Hq, Hkv)
        return {
            "x": _w((lambda *s: torch.randn(*s, dtype=torch.bfloat16) * 0.05)(B, Sq, D)),
            "k_cache": _w((lambda *s: torch.randn(*s, dtype=torch.bfloat16) * 0.8)(B, Hkv, Sk, Dh)),
            "v_cache": _w((lambda *s: torch.randn(*s, dtype=torch.bfloat16) * 0.8)(B, Hkv, Sk, Dh)),
            "wq": _w((lambda *s: torch.randn(*s, dtype=torch.bfloat16) * 0.8)(D, Hq * Dh) * (D ** -0.5)),
            "wo": _w((lambda *s: torch.randn(*s, dtype=torch.bfloat16) * 0.8)(Hq * Dh, D) * ((Hq * Dh) ** -0.5)),
        }
    _A_in = _A_setup()

    def _B_setup():
        B, S, D, Dff = 1, 1, 512, 1792
        return {
            "x": _w((lambda *s: torch.randn(*s, dtype=torch.bfloat16) * 0.05)(B, S, D)),
            "w1": _w((lambda *s: torch.randn(*s, dtype=torch.bfloat16) * 0.2)(D, Dff)),
            "w2": _w((lambda *s: torch.randn(*s, dtype=torch.bfloat16) * 0.2)(Dff, D)),
        }
    _B_in = _B_setup()

    return {
        "A_x": _A_in["x"],
        "A_k_cache": _A_in["k_cache"],
        "A_v_cache": _A_in["v_cache"],
        "A_wq": _A_in["wq"],
        "A_wo": _A_in["wo"],
        "B_x": _B_in["x"],
        "B_w1": _B_in["w1"],
        "B_w2": _B_in["w2"],
    }

def reference(A_x, A_k_cache, A_v_cache, A_wq, A_wo, B_x, B_w1, B_w2):
    def _A_ref(x, k_cache, v_cache, wq, wo):
        B, Sq, D = x.shape
        Hq, Dh = 32, 128
        Hkv = k_cache.shape[1]
        rep = Hq // Hkv
        q = (lambda x, *d: x.permute(*d))((x @ wq).reshape(B, Sq, Hq, Dh), 0, 2, 1, 3)
        k = (lambda x, n, axis: torch.repeat_interleave(x, n, dim=axis))(k_cache, rep, axis=1)
        v = (lambda x, n, axis: torch.repeat_interleave(x, n, dim=axis))(v_cache, rep, axis=1)
        scores = torch.einsum("bhqd,bhkd->bhqk", q, k) * (Dh ** -0.5)
        p = _softmax(scores, axis=-1)
        o = torch.einsum("bhqk,bhkd->bhqd", p, v)
        return (lambda x, *d: x.permute(*d))(o, 0, 2, 1, 3).reshape(B, Sq, Hq * Dh) @ wo

    def _B_ref(x, w1, w2):
        h = torch.einsum("bsd,df->bsf", x, w1)
        zero = torch.zeros_like(h)
        h = torch.maximum(h, zero)
        return torch.einsum("bsf,fd->bsd", h, w2)

    x = A_x
    xn = _layernorm(x, axis=-1)
    s = _A_ref(xn, A_k_cache, A_v_cache, A_wq, A_wo)
    g = _silu(_B_ref(xn, B_w1, B_w2))
    return x + s * g
```

```asm
; @launch grid=(256,1,1) block=(384,1,1) lds=10240
.amdgcn_target "amdgcn-amd-amdhsa--gfx950"
.text
.globl recurrent_scan__gqa_block_cached__dense_activation_relu__decode_kernel
.p2align 8
.type recurrent_scan__gqa_block_cached__dense_activation_relu__decode_kernel,@function
recurrent_scan__gqa_block_cached__dense_activation_relu__decode_kernel:
  s_cmp_lt_u32 s2, 256
  s_cbranch_scc1 L_go
  s_endpgm
L_go:
  s_load_dwordx16 s[16:31], s[0:1], 0
  s_load_dwordx4 s[32:35], s[0:1], 64
  s_load_dwordx2 s[36:37], s[0:1], 80
  v_lshrrev_b32 v3, 6, v0
  v_and_b32 v0, 63, v0
  v_readfirstlane_b32 s3, v3
  s_lshr_b32 s4, s2, 5
  s_and_b32 s5, s2, 31
  v_and_b32 v4, 15, v0
  v_lshrrev_b32 v5, 4, v0
  s_cmp_ge_u32 s3, 4
  s_cbranch_scc1 L_helper
  v_lshrrev_b32 v1, 2, v4
  v_lshlrev_b32 v1, 10, v1
  v_and_b32 v2, 2, v0
  v_lshl_add_u32 v1, v2, 7, v1
  v_and_b32 v2, 1, v0
  v_lshl_add_u32 v6, v5, 1, v2
  v_lshl_add_u32 v1, v6, 4, v1
  v_lshlrev_b32 v2, 10, v5
  v_lshl_add_u32 v2, v4, 4, v2
  s_andn2_b32 s7, s2, 1
  s_lshl_b32 s7, s7, 19
  s_and_b32 s8, s2, 1
  s_lshl_b32 s8, s8, 14
  s_add_u32 s7, s7, s8
  s_lshl_b32 s8, s3, 12
  s_add_u32 s7, s7, s8
  s_waitcnt lgkmcnt(0)
  s_mov_b32 s40, s18
  s_mov_b32 s41, s19
  s_mov_b32 s42, 0x8000000
  s_mov_b32 s43, 0x20000
  s_mov_b32 s44, s20
  s_mov_b32 s45, s21
  s_mov_b32 s46, 0x8000000
  s_mov_b32 s47, 0x20000
  s_barrier
  buffer_load_dwordx4 v[64:67], v1, s[40:43], s7 offen offset:0 nt
  buffer_load_dwordx4 v[68:71], v1, s[40:43], s7 offen offset:128 nt
  buffer_load_dwordx4 v[72:75], v1, s[40:43], s7 offen offset:512 nt
  buffer_load_dwordx4 v[76:79], v1, s[40:43], s7 offen offset:640 nt
  s_add_u32 s7, s7, 32768
  buffer_load_dwordx4 v[80:83], v1, s[40:43], s7 offen offset:0 nt
  s_load_dword s38, s[36:37], 0
  s_branch L_stream
L_helper:
  s_setprio 3
  v_lshlrev_b32 v6, 4, v0
  v_lshrrev_b32 v7, 3, v0
  v_and_b32 v202, 7, v0
  v_mov_b32 v206, 0xff
  s_cmp_eq_u32 s3, 5
  s_cbranch_scc1 L_w5
  s_lshr_b32 s8, s5, 3
  s_and_b32 s9, s5, 7
  s_lshl_b32 s10, s8, 8
  v_lshlrev_b32 v201, 5, v7
  v_add_u32 v201, s10, v201
  v_lshlrev_b32 v7, 17, v7
  v_lshl_add_u32 v7, v202, 4, v7
  s_lshl_b32 s10, s8, 20
  s_lshl_b32 s11, s4, 10
  s_add_u32 s10, s10, s11
  s_lshl_b32 s11, s9, 7
  s_add_u32 s10, s10, s11
  v_mov_b32 v197, 0
  v_mov_b32 v12, 0
  v_mov_b32 v13, 0
  v_mov_b32 v14, 0
  v_mov_b32 v15, 0
  ds_write_b128 v197, v[12:15] offset:9984
  ds_write_b32 v197, v197 offset:10000
  s_waitcnt lgkmcnt(0)
  s_load_dword s38, s[36:37], 0
  s_mov_b32 s48, s22
  s_mov_b32 s49, s23
  s_mov_b32 s50, 0x400000
  s_mov_b32 s51, 0x20000
  global_load_dwordx4 v[8:11], v6, s[16:17]
  global_load_dwordx4 v[20:23], v201, s[16:17]
  global_load_dwordx4 v[24:27], v201, s[16:17] offset:16
  buffer_load_dwordx4 v[128:131], v7, s[48:51], s10 offen nt
  s_add_u32 s10, s10, 0x2000
  buffer_load_dwordx4 v[132:135], v7, s[48:51], s10 offen nt
  s_add_u32 s10, s10, 0x2000
  buffer_load_dwordx4 v[136:139], v7, s[48:51], s10 offen nt
  s_add_u32 s10, s10, 0x2000
  buffer_load_dwordx4 v[140:143], v7, s[48:51], s10 offen nt
  s_add_u32 s10, s10, 0x2000
  buffer_load_dwordx4 v[144:147], v7, s[48:51], s10 offen nt
  s_add_u32 s10, s10, 0x2000
  buffer_load_dwordx4 v[148:151], v7, s[48:51], s10 offen nt
  s_add_u32 s10, s10, 0x2000
  buffer_load_dwordx4 v[152:155], v7, s[48:51], s10 offen nt
  s_add_u32 s10, s10, 0x2000
  buffer_load_dwordx4 v[156:159], v7, s[48:51], s10 offen nt
  s_add_u32 s10, s10, 0x2000
  buffer_load_dwordx4 v[160:163], v7, s[48:51], s10 offen nt
  s_add_u32 s10, s10, 0x2000
  buffer_load_dwordx4 v[164:167], v7, s[48:51], s10 offen nt
  s_add_u32 s10, s10, 0x2000
  buffer_load_dwordx4 v[168:171], v7, s[48:51], s10 offen nt
  s_add_u32 s10, s10, 0x2000
  buffer_load_dwordx4 v[172:175], v7, s[48:51], s10 offen nt
  s_add_u32 s10, s10, 0x2000
  buffer_load_dwordx4 v[176:179], v7, s[48:51], s10 offen nt
  s_add_u32 s10, s10, 0x2000
  buffer_load_dwordx4 v[180:183], v7, s[48:51], s10 offen nt
  s_add_u32 s10, s10, 0x2000
  buffer_load_dwordx4 v[184:187], v7, s[48:51], s10 offen nt
  s_add_u32 s10, s10, 0x2000
  buffer_load_dwordx4 v[188:191], v7, s[48:51], s10 offen nt
  s_barrier
  v_mov_b32 v28, 0
  v_mov_b32 v29, 0
  v_mov_b32 v30, 0
  v_mov_b32 v31, 0
  v_mov_b32 v32, 0
  v_mov_b32 v33, 0
  v_mov_b32 v34, 0
  v_mov_b32 v35, 0
  s_mov_b32 s52, s24
  s_mov_b32 s53, s25
  s_mov_b32 s54, 0x400000
  s_mov_b32 s55, 0x20000
  s_lshl_b32 s10, s2, 8
  s_add_u32 s10, s10, 4096
  v_lshrrev_b32 v203, 5, v0
  v_lshlrev_b32 v203, 7, v203
  v_lshl_add_u32 v203, v202, 4, v203
  v_add_u32 v203, s10, v203
  s_lshl_b32 s10, s4, 13
  s_add_u32 s10, s10, 4096
  v_add_u32 v204, s10, v6
  v_add_u32 v205, 4096, v204
  v_lshlrev_b32 v7, 10, v5
  v_lshl_add_u32 v7, v4, 4, v7
  s_lshr_b32 s6, s2, 2
  s_and_b32 s13, s2, 3
  s_lshl_b32 s14, s6, 16
  s_lshl_b32 s11, s13, 8
  s_add_u32 s14, s14, s11
  s_waitcnt vmcnt(16)
  v_lshlrev_b32 v12, 16, v8
  v_and_b32 v13, 0xffff0000, v8
  v_lshlrev_b32 v14, 16, v9
  v_and_b32 v15, 0xffff0000, v9
  v_lshlrev_b32 v16, 16, v10
  v_and_b32 v17, 0xffff0000, v10
  v_lshlrev_b32 v18, 16, v11
  v_and_b32 v19, 0xffff0000, v11
  v_add_f32 v116, v12, v13
  v_add_f32 v117, v14, v15
  v_add_f32 v118, v16, v17
  v_add_f32 v119, v18, v19
  v_add_f32 v116, v116, v117
  v_add_f32 v118, v118, v119
  v_add_f32 v116, v116, v118
  s_nop 1
  v_add_f32_dpp v116, v116, v116 row_ror:8 row_mask:0xf bank_mask:0xf
  v_lshlrev_b32 v36, 16, v20
  v_and_b32 v37, 0xffff0000, v20
  v_add_f32_dpp v116, v116, v116 row_ror:4 row_mask:0xf bank_mask:0xf
  v_lshlrev_b32 v38, 16, v21
  v_and_b32 v39, 0xffff0000, v21
  v_add_f32_dpp v116, v116, v116 row_ror:2 row_mask:0xf bank_mask:0xf
  v_lshlrev_b32 v40, 16, v22
  v_and_b32 v41, 0xffff0000, v22
  v_add_f32_dpp v116, v116, v116 row_ror:1 row_mask:0xf bank_mask:0xf
  v_lshlrev_b32 v42, 16, v23
  v_and_b32 v43, 0xffff0000, v23
  v_mov_b32 v117, v116
  v_lshlrev_b32 v44, 16, v24
  v_and_b32 v45, 0xffff0000, v24
  v_permlane16_swap_b32 v116, v117
  v_lshlrev_b32 v46, 16, v25
  v_and_b32 v47, 0xffff0000, v25
  v_add_f32 v116, v116, v117
  v_lshlrev_b32 v48, 16, v26
  v_and_b32 v49, 0xffff0000, v26
  v_mov_b32 v117, v116
  v_lshlrev_b32 v50, 16, v27
  v_and_b32 v51, 0xffff0000, v27
  v_permlane32_swap_b32 v116, v117
  v_add_f32 v116, v116, v117
  v_mul_f32 v116, 0x3b000000, v116
  v_sub_f32 v12, v12, v116
  v_sub_f32 v13, v13, v116
  v_sub_f32 v14, v14, v116
  v_sub_f32 v15, v15, v116
  v_sub_f32 v16, v16, v116
  v_sub_f32 v17, v17, v116
  v_sub_f32 v18, v18, v116
  v_sub_f32 v19, v19, v116
  v_mul_f32 v118, v12, v12
  v_mul_f32 v119, v13, v13
  v_fmac_f32 v118, v14, v14
  v_fmac_f32 v119, v15, v15
  v_fmac_f32 v118, v16, v16
  v_fmac_f32 v119, v17, v17
  v_fmac_f32 v118, v18, v18
  v_fmac_f32 v119, v19, v19
  v_add_f32 v118, v118, v119
  v_cvt_pk_bf16_f32 v116, 0, v116
  s_nop 0
  v_add_f32_dpp v118, v118, v118 row_ror:8 row_mask:0xf bank_mask:0xf
  v_sub_f32 v36, v36, v116
  v_sub_f32 v37, v37, v116
  v_add_f32_dpp v118, v118, v118 row_ror:4 row_mask:0xf bank_mask:0xf
  v_sub_f32 v38, v38, v116
  v_sub_f32 v39, v39, v116
  v_add_f32_dpp v118, v118, v118 row_ror:2 row_mask:0xf bank_mask:0xf
  v_sub_f32 v40, v40, v116
  v_sub_f32 v41, v41, v116
  v_add_f32_dpp v118, v118, v118 row_ror:1 row_mask:0xf bank_mask:0xf
  v_sub_f32 v42, v42, v116
  v_sub_f32 v43, v43, v116
  v_mov_b32 v117, v118
  v_sub_f32 v44, v44, v116
  v_sub_f32 v45, v45, v116
  v_permlane16_swap_b32 v118, v117
  v_sub_f32 v46, v46, v116
  v_sub_f32 v47, v47, v116
  v_add_f32 v118, v118, v117
  v_sub_f32 v48, v48, v116
  v_sub_f32 v49, v49, v116
  v_mov_b32 v117, v118
  v_sub_f32 v50, v50, v116
  v_sub_f32 v51, v51, v116
  v_permlane32_swap_b32 v118, v117
  v_cvt_pk_bf16_f32 v36, 0, v36
  v_cvt_pk_bf16_f32 v37, 0, v37
  v_add_f32 v118, v118, v117
  v_cvt_pk_bf16_f32 v38, 0, v38
  v_cvt_pk_bf16_f32 v39, 0, v39
  v_mul_f32 v118, 0x3b000000, v118
  v_cvt_pk_bf16_f32 v40, 0, v40
  v_cvt_pk_bf16_f32 v41, 0, v41
  v_cvt_pk_bf16_f32 v118, 0, v118
  v_cvt_pk_bf16_f32 v42, 0, v42
  v_cvt_pk_bf16_f32 v43, 0, v43
  v_add_f32 v118, 0x3727c5ac, v118
  v_cvt_pk_bf16_f32 v44, 0, v44
  v_cvt_pk_bf16_f32 v45, 0, v45
  v_cvt_pk_bf16_f32 v118, 0, v118
  v_cvt_pk_bf16_f32 v46, 0, v46
  v_cvt_pk_bf16_f32 v47, 0, v47
  v_sqrt_f32 v118, v118
  v_cvt_pk_bf16_f32 v48, 0, v48
  v_cvt_pk_bf16_f32 v49, 0, v49
  v_cvt_pk_bf16_f32 v118, 0, v118
  v_cvt_pk_bf16_f32 v50, 0, v50
  v_cvt_pk_bf16_f32 v51, 0, v51
  v_rcp_f32 v119, v118
  s_nop 0
  v_mul_f32 v52, v36, v119
  v_mul_f32 v53, v37, v119
  v_mul_f32 v54, v38, v119
  v_mul_f32 v55, v39, v119
  v_mul_f32 v56, v40, v119
  v_mul_f32 v57, v41, v119
  v_mul_f32 v58, v42, v119
  v_mul_f32 v59, v43, v119
  v_mul_f32 v60, v44, v119
  v_mul_f32 v61, v45, v119
  v_mul_f32 v62, v46, v119
  v_mul_f32 v63, v47, v119
  v_mul_f32 v64, v48, v119
  v_mul_f32 v65, v49, v119
  v_mul_f32 v66, v50, v119
  v_mul_f32 v67, v51, v119
  v_fma_f32 v36, -v52, v118, v36
  v_fma_f32 v37, -v53, v118, v37
  v_fma_f32 v38, -v54, v118, v38
  v_fma_f32 v39, -v55, v118, v39
  v_fma_f32 v40, -v56, v118, v40
  v_fma_f32 v41, -v57, v118, v41
  v_fma_f32 v42, -v58, v118, v42
  v_fma_f32 v43, -v59, v118, v43
  v_fma_f32 v44, -v60, v118, v44
  v_fma_f32 v45, -v61, v118, v45
  v_fma_f32 v46, -v62, v118, v46
  v_fma_f32 v47, -v63, v118, v47
  v_fma_f32 v48, -v64, v118, v48
  v_fma_f32 v49, -v65, v118, v49
  v_fma_f32 v50, -v66, v118, v50
  v_fma_f32 v51, -v67, v118, v51
  v_fmac_f32 v52, v36, v119
  v_fmac_f32 v53, v37, v119
  v_fmac_f32 v54, v38, v119
  v_fmac_f32 v55, v39, v119
  v_fmac_f32 v56, v40, v119
  v_fmac_f32 v57, v41, v119
  v_fmac_f32 v58, v42, v119
  v_fmac_f32 v59, v43, v119
  v_fmac_f32 v60, v44, v119
  v_fmac_f32 v61, v45, v119
  v_fmac_f32 v62, v46, v119
  v_fmac_f32 v63, v47, v119
  v_fmac_f32 v64, v48, v119
  v_fmac_f32 v65, v49, v119
  v_fmac_f32 v66, v50, v119
  v_fmac_f32 v67, v51, v119
  v_cvt_pk_bf16_f32 v36, v52, 0
  v_cvt_pk_bf16_f32 v37, v53, 0
  v_cvt_pk_bf16_f32 v38, v54, 0
  v_cvt_pk_bf16_f32 v39, v55, 0
  v_cvt_pk_bf16_f32 v40, v56, 0
  v_cvt_pk_bf16_f32 v41, v57, 0
  v_cvt_pk_bf16_f32 v42, v58, 0
  v_cvt_pk_bf16_f32 v43, v59, 0
  v_cvt_pk_bf16_f32 v44, v60, 0
  v_cvt_pk_bf16_f32 v45, v61, 0
  v_cvt_pk_bf16_f32 v46, v62, 0
  v_cvt_pk_bf16_f32 v47, v63, 0
  v_cvt_pk_bf16_f32 v48, v64, 0
  v_cvt_pk_bf16_f32 v49, v65, 0
  v_cvt_pk_bf16_f32 v50, v66, 0
  v_cvt_pk_bf16_f32 v51, v67, 0
  v_cvt_pk_bf16_f32 v52, 0, v52
  v_cvt_pk_bf16_f32 v53, 0, v53
  v_cvt_pk_bf16_f32 v54, 0, v54
  v_cvt_pk_bf16_f32 v55, 0, v55
  v_cvt_pk_bf16_f32 v56, 0, v56
  v_cvt_pk_bf16_f32 v57, 0, v57
  v_cvt_pk_bf16_f32 v58, 0, v58
  v_cvt_pk_bf16_f32 v59, 0, v59
  v_cvt_pk_bf16_f32 v60, 0, v60
  v_cvt_pk_bf16_f32 v61, 0, v61
  v_cvt_pk_bf16_f32 v62, 0, v62
  v_cvt_pk_bf16_f32 v63, 0, v63
  v_cvt_pk_bf16_f32 v64, 0, v64
  v_cvt_pk_bf16_f32 v65, 0, v65
  v_cvt_pk_bf16_f32 v66, 0, v66
  v_cvt_pk_bf16_f32 v67, 0, v67
  s_waitcnt vmcnt(15)
  v_dot2c_f32_bf16 v28, v128, v36
  v_dot2c_f32_bf16 v29, v128, v52
  v_dot2c_f32_bf16 v30, v129, v36
  v_dot2c_f32_bf16 v31, v129, v52
  v_dot2c_f32_bf16 v32, v130, v36
  v_dot2c_f32_bf16 v33, v130, v52
  v_dot2c_f32_bf16 v34, v131, v36
  v_dot2c_f32_bf16 v35, v131, v52
  s_waitcnt vmcnt(14)
  v_dot2c_f32_bf16 v28, v132, v37
  v_dot2c_f32_bf16 v29, v132, v53
  v_dot2c_f32_bf16 v30, v133, v37
  v_dot2c_f32_bf16 v31, v133, v53
  v_dot2c_f32_bf16 v32, v134, v37
  v_dot2c_f32_bf16 v33, v134, v53
  v_dot2c_f32_bf16 v34, v135, v37
  v_dot2c_f32_bf16 v35, v135, v53
  s_waitcnt vmcnt(13)
  v_dot2c_f32_bf16 v28, v136, v38
  v_dot2c_f32_bf16 v29, v136, v54
  v_dot2c_f32_bf16 v30, v137, v38
  v_dot2c_f32_bf16 v31, v137, v54
  v_dot2c_f32_bf16 v32, v138, v38
  v_dot2c_f32_bf16 v33, v138, v54
  v_dot2c_f32_bf16 v34, v139, v38
  v_dot2c_f32_bf16 v35, v139, v54
  s_waitcnt vmcnt(12)
  v_dot2c_f32_bf16 v28, v140, v39
  v_dot2c_f32_bf16 v29, v140, v55
  v_dot2c_f32_bf16 v30, v141, v39
  v_dot2c_f32_bf16 v31, v141, v55
  v_dot2c_f32_bf16 v32, v142, v39
  v_dot2c_f32_bf16 v33, v142, v55
  v_dot2c_f32_bf16 v34, v143, v39
  v_dot2c_f32_bf16 v35, v143, v55
  s_waitcnt vmcnt(11)
  v_dot2c_f32_bf16 v28, v144, v40
  v_dot2c_f32_bf16 v29, v144, v56
  v_dot2c_f32_bf16 v30, v145, v40
  v_dot2c_f32_bf16 v31, v145, v56
  v_dot2c_f32_bf16 v32, v146, v40
  v_dot2c_f32_bf16 v33, v146, v56
  v_dot2c_f32_bf16 v34, v147, v40
  v_dot2c_f32_bf16 v35, v147, v56
  s_waitcnt vmcnt(10)
  v_dot2c_f32_bf16 v28, v148, v41
  v_dot2c_f32_bf16 v29, v148, v57
  v_dot2c_f32_bf16 v30, v149, v41
  v_dot2c_f32_bf16 v31, v149, v57
  v_dot2c_f32_bf16 v32, v150, v41
  v_dot2c_f32_bf16 v33, v150, v57
  v_dot2c_f32_bf16 v34, v151, v41
  v_dot2c_f32_bf16 v35, v151, v57
  s_waitcnt vmcnt(9)
  v_dot2c_f32_bf16 v28, v152, v42
  v_dot2c_f32_bf16 v29, v152, v58
  v_dot2c_f32_bf16 v30, v153, v42
  v_dot2c_f32_bf16 v31, v153, v58
  v_dot2c_f32_bf16 v32, v154, v42
  v_dot2c_f32_bf16 v33, v154, v58
  v_dot2c_f32_bf16 v34, v155, v42
  v_dot2c_f32_bf16 v35, v155, v58
  s_waitcnt vmcnt(8)
  v_dot2c_f32_bf16 v28, v156, v43
  v_dot2c_f32_bf16 v29, v156, v59
  v_dot2c_f32_bf16 v30, v157, v43
  v_dot2c_f32_bf16 v31, v157, v59
  v_dot2c_f32_bf16 v32, v158, v43
  v_dot2c_f32_bf16 v33, v158, v59
  v_dot2c_f32_bf16 v34, v159, v43
  v_dot2c_f32_bf16 v35, v159, v59
  s_waitcnt vmcnt(7)
  v_dot2c_f32_bf16 v28, v160, v44
  v_dot2c_f32_bf16 v29, v160, v60
  v_dot2c_f32_bf16 v30, v161, v44
  v_dot2c_f32_bf16 v31, v161, v60
  v_dot2c_f32_bf16 v32, v162, v44
  v_dot2c_f32_bf16 v33, v162, v60
  v_dot2c_f32_bf16 v34, v163, v44
  v_dot2c_f32_bf16 v35, v163, v60
  s_waitcnt vmcnt(6)
  v_dot2c_f32_bf16 v28, v164, v45
  v_dot2c_f32_bf16 v29, v164, v61
  v_dot2c_f32_bf16 v30, v165, v45
  v_dot2c_f32_bf16 v31, v165, v61
  v_dot2c_f32_bf16 v32, v166, v45
  v_dot2c_f32_bf16 v33, v166, v61
  v_dot2c_f32_bf16 v34, v167, v45
  v_dot2c_f32_bf16 v35, v167, v61
  s_waitcnt vmcnt(5)
  v_dot2c_f32_bf16 v28, v168, v46
  v_dot2c_f32_bf16 v29, v168, v62
  v_dot2c_f32_bf16 v30, v169, v46
  v_dot2c_f32_bf16 v31, v169, v62
  v_dot2c_f32_bf16 v32, v170, v46
  v_dot2c_f32_bf16 v33, v170, v62
  v_dot2c_f32_bf16 v34, v171, v46
  v_dot2c_f32_bf16 v35, v171, v62
  s_waitcnt vmcnt(4)
  v_dot2c_f32_bf16 v28, v172, v47
  v_dot2c_f32_bf16 v29, v172, v63
  v_dot2c_f32_bf16 v30, v173, v47
  v_dot2c_f32_bf16 v31, v173, v63
  v_dot2c_f32_bf16 v32, v174, v47
  v_dot2c_f32_bf16 v33, v174, v63
  v_dot2c_f32_bf16 v34, v175, v47
  v_dot2c_f32_bf16 v35, v175, v63
  s_waitcnt vmcnt(3)
  v_dot2c_f32_bf16 v28, v176, v48
  v_dot2c_f32_bf16 v29, v176, v64
  v_dot2c_f32_bf16 v30, v177, v48
  v_dot2c_f32_bf16 v31, v177, v64
  v_dot2c_f32_bf16 v32, v178, v48
  v_dot2c_f32_bf16 v33, v178, v64
  v_dot2c_f32_bf16 v34, v179, v48
  v_dot2c_f32_bf16 v35, v179, v64
  s_waitcnt vmcnt(2)
  v_dot2c_f32_bf16 v28, v180, v49
  v_dot2c_f32_bf16 v29, v180, v65
  v_dot2c_f32_bf16 v30, v181, v49
  v_dot2c_f32_bf16 v31, v181, v65
  v_dot2c_f32_bf16 v32, v182, v49
  v_dot2c_f32_bf16 v33, v182, v65
  v_dot2c_f32_bf16 v34, v183, v49
  v_dot2c_f32_bf16 v35, v183, v65
  s_waitcnt vmcnt(1)
  v_dot2c_f32_bf16 v28, v184, v50
  v_dot2c_f32_bf16 v29, v184, v66
  v_dot2c_f32_bf16 v30, v185, v50
  v_dot2c_f32_bf16 v31, v185, v66
  v_dot2c_f32_bf16 v32, v186, v50
  v_dot2c_f32_bf16 v33, v186, v66
  v_dot2c_f32_bf16 v34, v187, v50
  v_dot2c_f32_bf16 v35, v187, v66
  s_waitcnt vmcnt(0)
  v_dot2c_f32_bf16 v28, v188, v51
  v_dot2c_f32_bf16 v29, v188, v67
  v_dot2c_f32_bf16 v30, v189, v51
  v_dot2c_f32_bf16 v31, v189, v67
  v_dot2c_f32_bf16 v32, v190, v51
  v_dot2c_f32_bf16 v33, v190, v67
  v_dot2c_f32_bf16 v34, v191, v51
  v_dot2c_f32_bf16 v35, v191, v67
  v_permlane32_swap_b32 v28, v32
  v_permlane32_swap_b32 v29, v33
  v_permlane32_swap_b32 v30, v34
  v_permlane32_swap_b32 v31, v35
  v_add_f32 v28, v28, v32
  v_add_f32 v29, v29, v33
  v_add_f32 v30, v30, v34
  v_add_f32 v31, v31, v35
  v_add_f32_dpp v28, v28, v28 row_ror:8 row_mask:0xf bank_mask:0xf
  v_add_f32_dpp v29, v29, v29 row_ror:8 row_mask:0xf bank_mask:0xf
  v_add_f32_dpp v30, v30, v30 row_ror:8 row_mask:0xf bank_mask:0xf
  v_add_f32_dpp v31, v31, v31 row_ror:8 row_mask:0xf bank_mask:0xf
  v_mov_b32 v32, v28
  v_mov_b32 v33, v29
  v_mov_b32 v34, v30
  v_mov_b32 v35, v31
  v_permlane16_swap_b32 v28, v32
  v_permlane16_swap_b32 v29, v33
  v_permlane16_swap_b32 v30, v34
  v_permlane16_swap_b32 v31, v35
  v_add_f32 v28, v28, v32
  v_add_f32 v29, v29, v33
  v_add_f32 v30, v30, v34
  v_add_f32 v31, v31, v35
  s_waitcnt lgkmcnt(0)
  s_mul_i32 s39, s38, 1664525
  s_add_u32 s39, s39, 1013904223
  s_lshr_b32 s81, s39, 8
  s_lshr_b32 s82, s39, 16
  s_lshr_b32 s83, s39, 24
  v_bfi_b32 v28, v206, s39, v28
  v_bfi_b32 v29, v206, s81, v29
  v_bfi_b32 v30, v206, s82, v30
  v_bfi_b32 v31, v206, s83, v31
  s_mov_b32 exec_lo, 0xff
  s_mov_b32 exec_hi, 0xff
  global_store_dwordx4 v203, v[28:31], s[36:37] sc1
  s_mov_b64 exec, -1
  buffer_load_dwordx4 v[64:67], v7, s[52:55], s14 offen nt
  s_add_u32 s14, s14, 0x2000
  buffer_load_dwordx4 v[68:71], v7, s[52:55], s14 offen nt
  s_add_u32 s14, s14, 0x2000
  buffer_load_dwordx4 v[72:75], v7, s[52:55], s14 offen nt
  s_add_u32 s14, s14, 0x2000
  buffer_load_dwordx4 v[76:79], v7, s[52:55], s14 offen nt
  s_add_u32 s14, s14, 0x2000
  buffer_load_dwordx4 v[80:83], v7, s[52:55], s14 offen nt
  s_add_u32 s14, s14, 0x2000
  buffer_load_dwordx4 v[84:87], v7, s[52:55], s14 offen nt
  s_add_u32 s14, s14, 0x2000
  buffer_load_dwordx4 v[88:91], v7, s[52:55], s14 offen nt
  s_add_u32 s14, s14, 0x2000
  buffer_load_dwordx4 v[92:95], v7, s[52:55], s14 offen nt
  s_sub_u32 s14, s14, 53248
  buffer_load_dwordx4 v[96:99], v7, s[52:55], s14 offen nt
  s_add_u32 s14, s14, 0x2000
  buffer_load_dwordx4 v[100:103], v7, s[52:55], s14 offen nt
  s_add_u32 s14, s14, 0x2000
  buffer_load_dwordx4 v[104:107], v7, s[52:55], s14 offen nt
  s_add_u32 s14, s14, 0x2000
  buffer_load_dwordx4 v[108:111], v7, s[52:55], s14 offen nt
  s_add_u32 s14, s14, 0x2000
  buffer_load_dwordx4 v[112:115], v7, s[52:55], s14 offen nt
  s_add_u32 s14, s14, 0x2000
  buffer_load_dwordx4 v[116:119], v7, s[52:55], s14 offen nt
  s_add_u32 s14, s14, 0x2000
  buffer_load_dwordx4 v[120:123], v7, s[52:55], s14 offen nt
  s_add_u32 s14, s14, 0x2000
  buffer_load_dwordx4 v[124:127], v7, s[52:55], s14 offen nt
  v_and_b32 v16, 1, v0
  v_lshlrev_b32 v16, 4, v16
  v_mov_b32 v17, 0xffff
  v_lshlrev_b32 v16, v16, v17
  v_lshrrev_b32 v17, 1, v4
  v_cmp_eq_u32 vcc, 0, v17
  s_nop 1
  v_cndmask_b32 v20, 0, v16, vcc
  v_cmp_eq_u32 vcc, 1, v17
  s_nop 1
  v_cndmask_b32 v21, 0, v16, vcc
  v_cmp_eq_u32 vcc, 2, v17
  s_nop 1
  v_cndmask_b32 v22, 0, v16, vcc
  v_cmp_eq_u32 vcc, 3, v17
  s_nop 1
  v_cndmask_b32 v23, 0, v16, vcc
  s_lshr_b32 s10, s2, 3
  s_lshl_b32 s10, s10, 9
  s_add_u32 s10, s10, 196608
  v_lshlrev_b32 v193, 6, v202
  v_lshl_add_u32 v193, v5, 4, v193
  v_add_u32 v193, s10, v193
  s_lshl_b32 s10, s6, 13
  s_add_u32 s10, s10, 524288
  v_add_u32 v194, s10, v6
  v_add_u32 v195, 4096, v194
  s_lshl_b32 s10, s13, 15
  s_lshl_b32 s11, s6, 6
  s_add_u32 s10, s10, s11
  s_add_u32 s10, s10, 262144
  v_lshrrev_b32 v196, 1, v4
  v_lshlrev_b32 v196, 12, v196
  v_and_b32 v16, 1, v0
  v_lshl_add_u32 v196, v16, 5, v196
  v_lshl_add_u32 v196, v5, 4, v196
  v_add_u32 v196, s10, v196
  v_lshlrev_b32 v198, 7, v5
  v_lshl_add_u32 v198, v202, 4, v198
  v_and_b32 v16, 8, v0
  v_add_u32 v198, v16, v198
  s_mov_b32 s12, 65536
  s_waitcnt vmcnt(0)
L_qpoll:
  global_load_dwordx4 v[128:131], v204, s[36:37] offset:0 sc1
  global_load_dwordx4 v[132:135], v204, s[36:37] offset:1024 sc1
  global_load_dwordx4 v[136:139], v204, s[36:37] offset:2048 sc1
  global_load_dwordx4 v[140:143], v204, s[36:37] offset:3072 sc1
  global_load_dwordx4 v[144:147], v205, s[36:37] offset:0 sc1
  global_load_dwordx4 v[148:151], v205, s[36:37] offset:1024 sc1
  global_load_dwordx4 v[152:155], v205, s[36:37] offset:2048 sc1
  global_load_dwordx4 v[156:159], v205, s[36:37] offset:3072 sc1
  s_waitcnt vmcnt(7)
  v_xor_b32 v16, s39, v128
  v_bitop3_b32 v16, v16, v129, s81 bitop3:0xf6
  v_bitop3_b32 v16, v16, v130, s82 bitop3:0xf6
  v_bitop3_b32 v16, v16, v131, s83 bitop3:0xf6
  s_waitcnt vmcnt(6)
  v_xor_b32 v17, s39, v132
  v_bitop3_b32 v17, v17, v133, s81 bitop3:0xf6
  v_bitop3_b32 v17, v17, v134, s82 bitop3:0xf6
  v_bitop3_b32 v17, v17, v135, s83 bitop3:0xf6
  s_waitcnt vmcnt(5)
  v_bitop3_b32 v16, v16, v136, s39 bitop3:0xf6
  v_bitop3_b32 v16, v16, v137, s81 bitop3:0xf6
  v_bitop3_b32 v16, v16, v138, s82 bitop3:0xf6
  v_bitop3_b32 v16, v16, v139, s83 bitop3:0xf6
  s_waitcnt vmcnt(4)
  v_bitop3_b32 v17, v17, v140, s39 bitop3:0xf6
  v_bitop3_b32 v17, v17, v141, s81 bitop3:0xf6
  v_bitop3_b32 v17, v17, v142, s82 bitop3:0xf6
  v_bitop3_b32 v17, v17, v143, s83 bitop3:0xf6
  s_waitcnt vmcnt(3)
  v_bitop3_b32 v16, v16, v144, s39 bitop3:0xf6
  v_bitop3_b32 v16, v16, v145, s81 bitop3:0xf6
  v_bitop3_b32 v16, v16, v146, s82 bitop3:0xf6
  v_bitop3_b32 v16, v16, v147, s83 bitop3:0xf6
  s_waitcnt vmcnt(2)
  v_bitop3_b32 v17, v17, v148, s39 bitop3:0xf6
  v_bitop3_b32 v17, v17, v149, s81 bitop3:0xf6
  v_bitop3_b32 v17, v17, v150, s82 bitop3:0xf6
  v_bitop3_b32 v17, v17, v151, s83 bitop3:0xf6
  s_waitcnt vmcnt(1)
  v_bitop3_b32 v16, v16, v152, s39 bitop3:0xf6
  v_bitop3_b32 v16, v16, v153, s81 bitop3:0xf6
  v_bitop3_b32 v16, v16, v154, s82 bitop3:0xf6
  v_bitop3_b32 v16, v16, v155, s83 bitop3:0xf6
  s_waitcnt vmcnt(0)
  v_bitop3_b32 v17, v17, v156, s39 bitop3:0xf6
  v_bitop3_b32 v17, v17, v157, s81 bitop3:0xf6
  v_bitop3_b32 v17, v17, v158, s82 bitop3:0xf6
  v_bitop3_b32 v17, v17, v159, s83 bitop3:0xf6
  v_or_b32 v16, v16, v17
  v_and_b32 v16, 0xff, v16
  s_sub_u32 s12, s12, 1
  v_cmp_ne_u32 vcc, 0, v16
  s_cbranch_scc1 L_qok
  s_cbranch_vccnz L_qpoll
L_qok:
  v_pk_add_f32 v[128:129], v[128:129], v[136:137]
  v_pk_add_f32 v[144:145], v[144:145], v[152:153]
  v_pk_add_f32 v[130:131], v[130:131], v[138:139]
  v_pk_add_f32 v[146:147], v[146:147], v[154:155]
  v_pk_add_f32 v[132:133], v[132:133], v[140:141]
  v_pk_add_f32 v[148:149], v[148:149], v[156:157]
  v_pk_add_f32 v[134:135], v[134:135], v[142:143]
  v_pk_add_f32 v[150:151], v[150:151], v[158:159]
  v_pk_add_f32 v[128:129], v[128:129], v[144:145]
  v_pk_add_f32 v[130:131], v[130:131], v[146:147]
  v_pk_add_f32 v[132:133], v[132:133], v[148:149]
  v_pk_add_f32 v[134:135], v[134:135], v[150:151]
  v_cvt_pk_bf16_f32 v128, v128, v129
  v_cvt_pk_bf16_f32 v129, v130, v131
  v_cvt_pk_bf16_f32 v132, v132, v133
  v_cvt_pk_bf16_f32 v133, v134, v135
  ds_write_b64 v198, v[128:129] offset:0
  ds_write_b64 v198, v[132:133] offset:512
  v_mov_b32 v16, 1
  ds_write_b32 v197, v16 offset:9984
  s_and_b32 s10, s2, 3
  s_mul_i32 s11, s10, 5
  s_lshr_b32 s14, s2, 2
  s_add_u32 s11, s11, s14
  s_and_b32 s11, s11, 63
  s_mul_i32 s11, s11, 4352
  s_add_u32 s11, s11, 1048576
  v_lshl_add_u32 v199, v0, 2, s11
  s_lshl_b32 s10, s10, 2
  s_add_u32 s10, s10, s11
  v_mov_b32 v198, s10
  v_mov_b32 v18, 0
  s_mov_b32 s12, 1048576
L_fw_k0:
  ds_read_b32 v19, v18 offset:10000
  s_sub_u32 s12, s12, 1
  s_cmp_eq_u32 s12, 0
  s_waitcnt lgkmcnt(0)
  s_cbranch_scc1 L_fw_k0_ok
  v_cmp_gt_u32 vcc, 256, v19
  s_cbranch_vccz L_fw_k0_ok
  s_sleep 4
  s_branch L_fw_k0
L_fw_k0_ok:
  s_mov_b64 exec, 1
  s_add_u32 s10, s39, 1
  v_mov_b32 v17, s10
  global_store_dword v198, v17, s[36:37] sc1
  s_mov_b64 exec, 0xf
  global_load_dword v17, v199, s[36:37] sc1
  s_waitcnt vmcnt(0)
  v_subrev_u32 v17, s10, v17
  v_cmp_gt_u32 vcc, 32, v17
  s_bcnt1_i32_b64 s10, vcc
  s_mov_b64 exec, 1
  s_cmp_ge_u32 s10, 4
  s_cselect_b64 vcc, -1, 0
  v_cndmask_b32 v17, 0, v16, vcc
  ds_write_b32 v197, v17 offset:9996
  s_mov_b64 exec, -1
  v_mov_b32 v18, 0
  s_mov_b32 s12, 1048576
L_fw_k1:
  ds_read_b32 v19, v18 offset:10000
  s_sub_u32 s12, s12, 1
  s_cmp_eq_u32 s12, 0
  s_waitcnt lgkmcnt(0)
  s_cbranch_scc1 L_fw_k1_ok
  v_cmp_gt_u32 vcc, 512, v19
  s_cbranch_vccz L_fw_k1_ok
  s_sleep 4
  s_branch L_fw_k1
L_fw_k1_ok:
  s_mov_b64 exec, 1
  s_add_u32 s10, s39, 2
  v_mov_b32 v17, s10
  global_store_dword v198, v17, s[36:37] sc1
  s_mov_b64 exec, 0xf
  global_load_dword v17, v199, s[36:37] sc1
  s_waitcnt vmcnt(0)
  v_subrev_u32 v17, s10, v17
  v_cmp_gt_u32 vcc, 32, v17
  s_bcnt1_i32_b64 s10, vcc
  s_mov_b64 exec, 1
  s_cmp_ge_u32 s10, 4
  s_cselect_b64 vcc, -1, 0
  v_cndmask_b32 v17, 0, v16, vcc
  ds_write_b32 v197, v17 offset:9996
  s_mov_b64 exec, -1
  v_mov_b32 v18, 0
  s_mov_b32 s12, 1048576
L_fw_k2:
  ds_read_b32 v19, v18 offset:10000
  s_sub_u32 s12, s12, 1
  s_cmp_eq_u32 s12, 0
  s_waitcnt lgkmcnt(0)
  s_cbranch_scc1 L_fw_k2_ok
  v_cmp_gt_u32 vcc, 768, v19
  s_cbranch_vccz L_fw_k2_ok
  s_sleep 4
  s_branch L_fw_k2
L_fw_k2_ok:
  s_mov_b64 exec, 1
  s_add_u32 s10, s39, 3
  v_mov_b32 v17, s10
  global_store_dword v198, v17, s[36:37] sc1
  s_mov_b64 exec, 0xf
  global_load_dword v17, v199, s[36:37] sc1
  s_waitcnt vmcnt(0)
  v_subrev_u32 v17, s10, v17
  v_cmp_gt_u32 vcc, 32, v17
  s_bcnt1_i32_b64 s10, vcc
  s_mov_b64 exec, 1
  s_cmp_ge_u32 s10, 4
  s_cselect_b64 vcc, -1, 0
  v_cndmask_b32 v17, 0, v16, vcc
  ds_write_b32 v197, v17 offset:9996
  s_mov_b64 exec, -1
  v_mov_b32 v18, 0
  s_mov_b32 s12, 1048576
L_fw_k3:
  ds_read_b32 v19, v18 offset:10000
  s_sub_u32 s12, s12, 1
  s_cmp_eq_u32 s12, 0
  s_waitcnt lgkmcnt(0)
  s_cbranch_scc1 L_fw_k3_ok
  v_cmp_gt_u32 vcc, 1024, v19
  s_cbranch_vccz L_fw_k3_ok
  s_sleep 4
  s_branch L_fw_k3
L_fw_k3_ok:
  s_mov_b64 exec, 1
  s_add_u32 s10, s39, 4
  v_mov_b32 v17, s10
  global_store_dword v198, v17, s[36:37] sc1
  s_mov_b64 exec, 0xf
  global_load_dword v17, v199, s[36:37] sc1
  s_waitcnt vmcnt(0)
  v_subrev_u32 v17, s10, v17
  v_cmp_gt_u32 vcc, 32, v17
  s_bcnt1_i32_b64 s10, vcc
  s_mov_b64 exec, 1
  s_cmp_ge_u32 s10, 4
  s_cselect_b64 vcc, -1, 0
  v_cndmask_b32 v17, 0, v16, vcc
  ds_write_b32 v197, v17 offset:9996
  s_mov_b64 exec, -1
  v_mov_b32 v18, 0
  s_mov_b32 s12, 1048576
L_fw_p:
  ds_read_b32 v19, v18 offset:9992
  s_sub_u32 s12, s12, 1
  s_cmp_eq_u32 s12, 0
  s_waitcnt lgkmcnt(0)
  s_cbranch_scc1 L_fw_p_ok
  v_cmp_gt_u32 vcc, 1, v19
  s_cbranch_vccz L_fw_p_ok
  s_sleep 8
  s_branch L_fw_p
L_fw_p_ok:
  s_mov_b32 s12, 65536
  s_mov_b64 s[58:59], -1
  s_mov_b64 s[60:61], -1
  s_mov_b64 s[62:63], -1
  s_mov_b64 s[64:65], -1
  s_mov_b64 s[66:67], -1
  s_mov_b64 s[68:69], -1
  s_mov_b64 s[70:71], -1
  s_mov_b64 s[72:73], -1
L_lp:
  global_load_dwordx4 v[8:11], v193, s[36:37] sc1
  s_sub_u32 s12, s12, 1
  s_cbranch_scc1 L_lpok
  s_waitcnt vmcnt(0)
  v_cmp_ne_u32 s[56:57], s39, v10
  s_bcnt1_i32_b64 s14, s[56:57]
  s_cmp_le_u32 s14, 12
  s_cbranch_scc1 L_lpok
  s_sleep 4
  s_branch L_lp
L_lpok:
  s_mov_b32 s12, 65536
L_h1poll:
  s_mov_b64 exec, s[56:57]
  s_cbranch_execz L_h1m
  global_load_dwordx4 v[8:11], v193, s[36:37] sc1
L_h1m:
  s_mov_b64 exec, s[58:59]
  s_cbranch_execz L_h1s0
  global_load_dwordx4 v[128:131], v194, s[36:37] offset:0 sc1
L_h1s0:
  s_mov_b64 exec, s[60:61]
  s_cbranch_execz L_h1s1
  global_load_dwordx4 v[132:135], v194, s[36:37] offset:1024 sc1
L_h1s1:
  s_mov_b64 exec, s[62:63]
  s_cbranch_execz L_h1s2
  global_load_dwordx4 v[136:139], v194, s[36:37] offset:2048 sc1
L_h1s2:
  s_mov_b64 exec, s[64:65]
  s_cbranch_execz L_h1s3
  global_load_dwordx4 v[140:143], v194, s[36:37] offset:3072 sc1
L_h1s3:
  s_mov_b64 exec, s[66:67]
  s_cbranch_execz L_h1s4
  global_load_dwordx4 v[144:147], v195, s[36:37] offset:0 sc1
L_h1s4:
  s_mov_b64 exec, s[68:69]
  s_cbranch_execz L_h1s5
  global_load_dwordx4 v[148:151], v195, s[36:37] offset:1024 sc1
L_h1s5:
  s_mov_b64 exec, s[70:71]
  s_cbranch_execz L_h1s6
  global_load_dwordx4 v[152:155], v195, s[36:37] offset:2048 sc1
L_h1s6:
  s_mov_b64 exec, s[72:73]
  s_cbranch_execz L_h1s7
  global_load_dwordx4 v[156:159], v195, s[36:37] offset:3072 sc1
L_h1s7:
  s_mov_b64 exec, -1
  s_sub_u32 s12, s12, 1
  s_cselect_b64 s[74:75], 0, -1
  s_waitcnt vmcnt(0)
  v_mov_b32 v24, v8
  v_cmp_ne_u32 s[56:57], s39, v10
  s_nop 0
  v_min_f32_dpp v24, v24, v24 row_ror:4 row_mask:0xf bank_mask:0xf
  v_xor_b32 v16, s39, v128
  v_xor_b32 v17, s39, v132
  v_bitop3_b32 v16, v16, v129, s81 bitop3:0xf6
  v_bitop3_b32 v17, v17, v133, s81 bitop3:0xf6
  v_min_f32_dpp v24, v24, v24 row_ror:2 row_mask:0xf bank_mask:0xf
  v_bitop3_b32 v16, v16, v130, s82 bitop3:0xf6
  v_bitop3_b32 v17, v17, v134, s82 bitop3:0xf6
  v_bitop3_b32 v16, v16, v131, s83 bitop3:0xf6
  v_bitop3_b32 v17, v17, v135, s83 bitop3:0xf6
  v_min_f32_dpp v24, v24, v24 row_ror:1 row_mask:0xf bank_mask:0xf
  v_cmp_ne_u32_sdwa s[58:59], v16, v197 src0_sel:BYTE_0 src1_sel:DWORD
  v_cmp_ne_u32_sdwa s[60:61], v17, v197 src0_sel:BYTE_0 src1_sel:DWORD
  v_xor_b32 v16, s39, v136
  v_xor_b32 v17, s39, v140
  v_mov_b32 v25, v24
  v_bitop3_b32 v16, v16, v137, s81 bitop3:0xf6
  v_bitop3_b32 v17, v17, v141, s81 bitop3:0xf6
  v_bitop3_b32 v16, v16, v138, s82 bitop3:0xf6
  v_bitop3_b32 v17, v17, v142, s82 bitop3:0xf6
  v_permlane16_swap_b32 v24, v25
  v_bitop3_b32 v16, v16, v139, s83 bitop3:0xf6
  v_bitop3_b32 v17, v17, v143, s83 bitop3:0xf6
  v_cmp_ne_u32_sdwa s[62:63], v16, v197 src0_sel:BYTE_0 src1_sel:DWORD
  v_cmp_ne_u32_sdwa s[64:65], v17, v197 src0_sel:BYTE_0 src1_sel:DWORD
  v_min_f32 v24, v24, v25
  s_or_b64 s[14:15], s[58:59], s[60:61]
  s_or_b64 s[10:11], s[14:15], s[56:57]
  v_xor_b32 v16, s39, v144
  v_xor_b32 v17, s39, v148
  v_mov_b32 v25, v24
  v_bitop3_b32 v16, v16, v145, s81 bitop3:0xf6
  v_bitop3_b32 v17, v17, v149, s81 bitop3:0xf6
  v_bitop3_b32 v16, v16, v146, s82 bitop3:0xf6
  v_bitop3_b32 v17, v17, v150, s82 bitop3:0xf6
  v_permlane32_swap_b32 v24, v25
  v_bitop3_b32 v16, v16, v147, s83 bitop3:0xf6
  v_bitop3_b32 v17, v17, v151, s83 bitop3:0xf6
  v_cmp_ne_u32_sdwa s[66:67], v16, v197 src0_sel:BYTE_0 src1_sel:DWORD
  v_cmp_ne_u32_sdwa s[68:69], v17, v197 src0_sel:BYTE_0 src1_sel:DWORD
  v_min_f32 v24, v24, v25
  s_or_b64 s[14:15], s[62:63], s[64:65]
  s_or_b64 s[10:11], s[14:15], s[10:11]
  v_xor_b32 v16, s39, v152
  v_xor_b32 v17, s39, v156
  v_sub_f32 v26, v24, v8
  v_bitop3_b32 v16, v16, v153, s81 bitop3:0xf6
  v_bitop3_b32 v17, v17, v157, s81 bitop3:0xf6
  v_bitop3_b32 v16, v16, v154, s82 bitop3:0xf6
  v_bitop3_b32 v17, v17, v158, s82 bitop3:0xf6
  v_exp_f32 v26, v26
  v_bitop3_b32 v16, v16, v155, s83 bitop3:0xf6
  v_bitop3_b32 v17, v17, v159, s83 bitop3:0xf6
  v_cmp_ne_u32_sdwa s[70:71], v16, v197 src0_sel:BYTE_0 src1_sel:DWORD
  v_cmp_ne_u32_sdwa s[72:73], v17, v197 src0_sel:BYTE_0 src1_sel:DWORD
  v_mul_f32 v30, v26, v9
  s_or_b64 s[14:15], s[66:67], s[68:69]
  s_or_b64 s[10:11], s[14:15], s[10:11]
  s_or_b64 s[14:15], s[70:71], s[72:73]
  s_or_b64 s[10:11], s[14:15], s[10:11]
  s_and_b64 s[10:11], s[10:11], s[74:75]
  s_cbranch_scc1 L_h1poll
  v_add_f32_dpp v30, v30, v30 row_ror:4 row_mask:0xf bank_mask:0xf
  v_mul_f32_dpp v12, v26, v128 row_newbcast:0 row_mask:0xf bank_mask:0xf
  v_mul_f32_dpp v13, v26, v129 row_newbcast:0 row_mask:0xf bank_mask:0xf
  v_mul_f32_dpp v14, v26, v130 row_newbcast:0 row_mask:0xf bank_mask:0xf
  v_add_f32_dpp v30, v30, v30 row_ror:2 row_mask:0xf bank_mask:0xf
  v_mul_f32_dpp v15, v26, v131 row_newbcast:0 row_mask:0xf bank_mask:0xf
  v_fmac_f32_dpp v12, v26, v132 row_newbcast:1 row_mask:0xf bank_mask:0xf
  v_fmac_f32_dpp v13, v26, v133 row_newbcast:1 row_mask:0xf bank_mask:0xf
  v_add_f32_dpp v30, v30, v30 row_ror:1 row_mask:0xf bank_mask:0xf
  v_fmac_f32_dpp v14, v26, v134 row_newbcast:1 row_mask:0xf bank_mask:0xf
  v_fmac_f32_dpp v15, v26, v135 row_newbcast:1 row_mask:0xf bank_mask:0xf
  v_fmac_f32_dpp v12, v26, v136 row_newbcast:2 row_mask:0xf bank_mask:0xf
  v_mov_b32 v25, v30
  v_fmac_f32_dpp v13, v26, v137 row_newbcast:2 row_mask:0xf bank_mask:0xf
  v_fmac_f32_dpp v14, v26, v138 row_newbcast:2 row_mask:0xf bank_mask:0xf
  v_fmac_f32_dpp v15, v26, v139 row_newbcast:2 row_mask:0xf bank_mask:0xf
  v_permlane16_swap_b32 v30, v25
  v_fmac_f32_dpp v12, v26, v140 row_newbcast:3 row_mask:0xf bank_mask:0xf
  v_fmac_f32_dpp v13, v26, v141 row_newbcast:3 row_mask:0xf bank_mask:0xf
  v_fmac_f32_dpp v14, v26, v142 row_newbcast:3 row_mask:0xf bank_mask:0xf
  v_add_f32 v30, v30, v25
  v_fmac_f32_dpp v15, v26, v143 row_newbcast:3 row_mask:0xf bank_mask:0xf
  v_fmac_f32_dpp v12, v26, v144 row_newbcast:4 row_mask:0xf bank_mask:0xf
  v_fmac_f32_dpp v13, v26, v145 row_newbcast:4 row_mask:0xf bank_mask:0xf
  v_mov_b32 v25, v30
  v_fmac_f32_dpp v14, v26, v146 row_newbcast:4 row_mask:0xf bank_mask:0xf
  v_fmac_f32_dpp v15, v26, v147 row_newbcast:4 row_mask:0xf bank_mask:0xf
  v_fmac_f32_dpp v12, v26, v148 row_newbcast:5 row_mask:0xf bank_mask:0xf
  v_permlane32_swap_b32 v30, v25
  v_fmac_f32_dpp v13, v26, v149 row_newbcast:5 row_mask:0xf bank_mask:0xf
  v_fmac_f32_dpp v14, v26, v150 row_newbcast:5 row_mask:0xf bank_mask:0xf
  v_fmac_f32_dpp v15, v26, v151 row_newbcast:5 row_mask:0xf bank_mask:0xf
  v_add_f32 v30, v30, v25
  v_fmac_f32_dpp v12, v26, v152 row_newbcast:6 row_mask:0xf bank_mask:0xf
  v_fmac_f32_dpp v13, v26, v153 row_newbcast:6 row_mask:0xf bank_mask:0xf
  v_fmac_f32_dpp v14, v26, v154 row_newbcast:6 row_mask:0xf bank_mask:0xf
  v_rcp_f32 v30, v30
  v_fmac_f32_dpp v15, v26, v155 row_newbcast:6 row_mask:0xf bank_mask:0xf
  v_fmac_f32_dpp v12, v26, v156 row_newbcast:7 row_mask:0xf bank_mask:0xf
  v_fmac_f32_dpp v13, v26, v157 row_newbcast:7 row_mask:0xf bank_mask:0xf
  v_fmac_f32_dpp v14, v26, v158 row_newbcast:7 row_mask:0xf bank_mask:0xf
  v_fmac_f32_dpp v15, v26, v159 row_newbcast:7 row_mask:0xf bank_mask:0xf
  s_nop 0
  v_permlane32_swap_b32 v12, v14
  v_permlane32_swap_b32 v13, v15
  v_add_f32 v12, v12, v14
  v_add_f32 v13, v13, v15
  s_nop 1
  v_permlane16_swap_b32 v12, v13
  v_add_f32 v12, v12, v13
  v_mul_f32 v12, v12, v30
  v_cvt_pk_bf16_f32 v12, v12, v12
  s_nop 1
  v_and_b32_dpp v32, v12, v20 row_newbcast:0 row_mask:0xf bank_mask:0xf
  v_and_b32_dpp v33, v12, v21 row_newbcast:0 row_mask:0xf bank_mask:0xf
  v_and_b32_dpp v34, v12, v22 row_newbcast:0 row_mask:0xf bank_mask:0xf
  v_and_b32_dpp v35, v12, v23 row_newbcast:0 row_mask:0xf bank_mask:0xf
  v_and_b32_dpp v36, v12, v20 row_newbcast:1 row_mask:0xf bank_mask:0xf
  v_and_b32_dpp v37, v12, v21 row_newbcast:1 row_mask:0xf bank_mask:0xf
  v_and_b32_dpp v38, v12, v22 row_newbcast:1 row_mask:0xf bank_mask:0xf
  v_and_b32_dpp v39, v12, v23 row_newbcast:1 row_mask:0xf bank_mask:0xf
  v_mfma_f32_16x16x32_bf16 v[44:47], v[32:35], v[64:67], 0
  v_and_b32_dpp v40, v12, v20 row_newbcast:2 row_mask:0xf bank_mask:0xf
  v_and_b32_dpp v41, v12, v21 row_newbcast:2 row_mask:0xf bank_mask:0xf
  v_and_b32_dpp v42, v12, v22 row_newbcast:2 row_mask:0xf bank_mask:0xf
  v_and_b32_dpp v43, v12, v23 row_newbcast:2 row_mask:0xf bank_mask:0xf
  v_mfma_f32_16x16x32_bf16 v[44:47], v[36:39], v[68:71], v[44:47]
  v_and_b32_dpp v32, v12, v20 row_newbcast:3 row_mask:0xf bank_mask:0xf
  v_and_b32_dpp v33, v12, v21 row_newbcast:3 row_mask:0xf bank_mask:0xf
  v_and_b32_dpp v34, v12, v22 row_newbcast:3 row_mask:0xf bank_mask:0xf
  v_and_b32_dpp v35, v12, v23 row_newbcast:3 row_mask:0xf bank_mask:0xf
  v_mfma_f32_16x16x32_bf16 v[44:47], v[40:43], v[72:75], v[44:47]
  v_and_b32_dpp v36, v12, v20 row_newbcast:4 row_mask:0xf bank_mask:0xf
  v_and_b32_dpp v37, v12, v21 row_newbcast:4 row_mask:0xf bank_mask:0xf
  v_and_b32_dpp v38, v12, v22 row_newbcast:4 row_mask:0xf bank_mask:0xf
  v_and_b32_dpp v39, v12, v23 row_newbcast:4 row_mask:0xf bank_mask:0xf
  v_mfma_f32_16x16x32_bf16 v[44:47], v[32:35], v[76:79], v[44:47]
  v_and_b32_dpp v40, v12, v20 row_newbcast:5 row_mask:0xf bank_mask:0xf
  v_and_b32_dpp v41, v12, v21 row_newbcast:5 row_mask:0xf bank_mask:0xf
  v_and_b32_dpp v42, v12, v22 row_newbcast:5 row_mask:0xf bank_mask:0xf
  v_and_b32_dpp v43, v12, v23 row_newbcast:5 row_mask:0xf bank_mask:0xf
  v_mfma_f32_16x16x32_bf16 v[44:47], v[36:39], v[80:83], v[44:47]
  v_and_b32_dpp v32, v12, v20 row_newbcast:6 row_mask:0xf bank_mask:0xf
  v_and_b32_dpp v33, v12, v21 row_newbcast:6 row_mask:0xf bank_mask:0xf
  v_and_b32_dpp v34, v12, v22 row_newbcast:6 row_mask:0xf bank_mask:0xf
  v_and_b32_dpp v35, v12, v23 row_newbcast:6 row_mask:0xf bank_mask:0xf
  v_mfma_f32_16x16x32_bf16 v[44:47], v[40:43], v[84:87], v[44:47]
  v_and_b32_dpp v36, v12, v20 row_newbcast:7 row_mask:0xf bank_mask:0xf
  v_and_b32_dpp v37, v12, v21 row_newbcast:7 row_mask:0xf bank_mask:0xf
  v_and_b32_dpp v38, v12, v22 row_newbcast:7 row_mask:0xf bank_mask:0xf
  v_and_b32_dpp v39, v12, v23 row_newbcast:7 row_mask:0xf bank_mask:0xf
  v_mfma_f32_16x16x32_bf16 v[44:47], v[32:35], v[88:91], v[44:47]
  v_and_b32_dpp v40, v12, v20 row_newbcast:8 row_mask:0xf bank_mask:0xf
  v_and_b32_dpp v41, v12, v21 row_newbcast:8 row_mask:0xf bank_mask:0xf
  v_and_b32_dpp v42, v12, v22 row_newbcast:8 row_mask:0xf bank_mask:0xf
  v_and_b32_dpp v43, v12, v23 row_newbcast:8 row_mask:0xf bank_mask:0xf
  v_mfma_f32_16x16x32_bf16 v[44:47], v[36:39], v[92:95], v[44:47]
  v_and_b32_dpp v32, v12, v20 row_newbcast:9 row_mask:0xf bank_mask:0xf
  v_and_b32_dpp v33, v12, v21 row_newbcast:9 row_mask:0xf bank_mask:0xf
  v_and_b32_dpp v34, v12, v22 row_newbcast:9 row_mask:0xf bank_mask:0xf
  v_and_b32_dpp v35, v12, v23 row_newbcast:9 row_mask:0xf bank_mask:0xf
  v_mfma_f32_16x16x32_bf16 v[44:47], v[40:43], v[96:99], v[44:47]
  v_and_b32_dpp v36, v12, v20 row_newbcast:10 row_mask:0xf bank_mask:0xf
  v_and_b32_dpp v37, v12, v21 row_newbcast:10 row_mask:0xf bank_mask:0xf
  v_and_b32_dpp v38, v12, v22 row_newbcast:10 row_mask:0xf bank_mask:0xf
  v_and_b32_dpp v39, v12, v23 row_newbcast:10 row_mask:0xf bank_mask:0xf
  v_mfma_f32_16x16x32_bf16 v[44:47], v[32:35], v[100:103], v[44:47]
  v_and_b32_dpp v40, v12, v20 row_newbcast:11 row_mask:0xf bank_mask:0xf
  v_and_b32_dpp v41, v12, v21 row_newbcast:11 row_mask:0xf bank_mask:0xf
  v_and_b32_dpp v42, v12, v22 row_newbcast:11 row_mask:0xf bank_mask:0xf
  v_and_b32_dpp v43, v12, v23 row_newbcast:11 row_mask:0xf bank_mask:0xf
  v_mfma_f32_16x16x32_bf16 v[44:47], v[36:39], v[104:107], v[44:47]
  v_and_b32_dpp v32, v12, v20 row_newbcast:12 row_mask:0xf bank_mask:0xf
  v_and_b32_dpp v33, v12, v21 row_newbcast:12 row_mask:0xf bank_mask:0xf
  v_and_b32_dpp v34, v12, v22 row_newbcast:12 row_mask:0xf bank_mask:0xf
  v_and_b32_dpp v35, v12, v23 row_newbcast:12 row_mask:0xf bank_mask:0xf
  v_mfma_f32_16x16x32_bf16 v[44:47], v[40:43], v[108:111], v[44:47]
  v_and_b32_dpp v36, v12, v20 row_newbcast:13 row_mask:0xf bank_mask:0xf
  v_and_b32_dpp v37, v12, v21 row_newbcast:13 row_mask:0xf bank_mask:0xf
  v_and_b32_dpp v38, v12, v22 row_newbcast:13 row_mask:0xf bank_mask:0xf
  v_and_b32_dpp v39, v12, v23 row_newbcast:13 row_mask:0xf bank_mask:0xf
  v_mfma_f32_16x16x32_bf16 v[44:47], v[32:35], v[112:115], v[44:47]
  v_and_b32_dpp v40, v12, v20 row_newbcast:14 row_mask:0xf bank_mask:0xf
  v_and_b32_dpp v41, v12, v21 row_newbcast:14 row_mask:0xf bank_mask:0xf
  v_and_b32_dpp v42, v12, v22 row_newbcast:14 row_mask:0xf bank_mask:0xf
  v_and_b32_dpp v43, v12, v23 row_newbcast:14 row_mask:0xf bank_mask:0xf
  v_mfma_f32_16x16x32_bf16 v[44:47], v[36:39], v[116:119], v[44:47]
  v_and_b32_dpp v32, v12, v20 row_newbcast:15 row_mask:0xf bank_mask:0xf
  v_and_b32_dpp v33, v12, v21 row_newbcast:15 row_mask:0xf bank_mask:0xf
  v_and_b32_dpp v34, v12, v22 row_newbcast:15 row_mask:0xf bank_mask:0xf
  v_and_b32_dpp v35, v12, v23 row_newbcast:15 row_mask:0xf bank_mask:0xf
  v_mfma_f32_16x16x32_bf16 v[44:47], v[40:43], v[120:123], v[44:47]
  s_nop 0
  v_mfma_f32_16x16x32_bf16 v[44:47], v[32:35], v[124:127], v[44:47]
  s_mov_b32 exec_hi, 0
  s_nop 6
  v_bfi_b32 v44, v206, s39, v44
  v_bfi_b32 v45, v206, s81, v45
  v_bfi_b32 v46, v206, s82, v46
  v_bfi_b32 v47, v206, s83, v47
  global_store_dwordx4 v196, v[44:47], s[36:37] sc1
  ds_write_b32 v197, v206 offset:9984
  s_endpgm
L_w5:
  s_cmp_lt_u32 s5, 4
  s_cbranch_scc1 L_fin
  s_mul_i32 s13, s4, 28
  s_add_u32 s13, s13, s5
  s_sub_u32 s13, s13, 4
  s_and_b32 s8, s13, 7
  s_lshr_b32 s9, s13, 3
  s_lshl_b32 s10, s8, 7
  v_lshlrev_b32 v120, 4, v7
  v_add_u32 v120, s10, v120
  v_mul_u32_u24 v121, 28672, v7
  v_lshl_add_u32 v121, v202, 4, v121
  s_mul_i32 s10, s8, 229376
  s_lshl_b32 s11, s9, 7
  s_add_u32 s10, s10, s11
  s_waitcnt lgkmcnt(0)
  s_load_dword s38, s[36:37], 0
  s_mov_b32 s48, s28
  s_mov_b32 s49, s29
  s_mov_b32 s50, 0x1c0000
  s_mov_b32 s51, 0x20000
  global_load_dwordx4 v[8:11], v6, s[16:17]
  global_load_dwordx4 v[20:23], v120, s[16:17]
  buffer_load_dwordx4 v[128:131], v121, s[48:51], s10 offen nt
  s_add_u32 s10, s10, 3584
  buffer_load_dwordx4 v[132:135], v121, s[48:51], s10 offen nt
  s_add_u32 s10, s10, 3584
  buffer_load_dwordx4 v[136:139], v121, s[48:51], s10 offen nt
  s_add_u32 s10, s10, 3584
  buffer_load_dwordx4 v[140:143], v121, s[48:51], s10 offen nt
  s_add_u32 s10, s10, 3584
  buffer_load_dwordx4 v[144:147], v121, s[48:51], s10 offen nt
  s_add_u32 s10, s10, 3584
  buffer_load_dwordx4 v[148:151], v121, s[48:51], s10 offen nt
  s_add_u32 s10, s10, 3584
  buffer_load_dwordx4 v[152:155], v121, s[48:51], s10 offen nt
  s_add_u32 s10, s10, 3584
  buffer_load_dwordx4 v[156:159], v121, s[48:51], s10 offen nt
  s_barrier
  v_mov_b32 v28, 0
  v_mov_b32 v29, 0
  v_mov_b32 v30, 0
  v_mov_b32 v31, 0
  v_mov_b32 v32, 0
  v_mov_b32 v33, 0
  v_mov_b32 v34, 0
  v_mov_b32 v35, 0
  s_lshl_b32 s10, s13, 8
  s_add_u32 s10, s10, 69632
  v_lshrrev_b32 v124, 5, v0
  v_lshlrev_b32 v122, 7, v124
  v_lshl_add_u32 v122, v202, 4, v122
  v_add_u32 v122, s10, v122
  s_waitcnt vmcnt(8)
  v_lshlrev_b32 v12, 16, v8
  v_and_b32 v13, 0xffff0000, v8
  v_lshlrev_b32 v14, 16, v9
  v_and_b32 v15, 0xffff0000, v9
  v_lshlrev_b32 v16, 16, v10
  v_and_b32 v17, 0xffff0000, v10
  v_lshlrev_b32 v18, 16, v11
  v_and_b32 v19, 0xffff0000, v11
  v_add_f32 v116, v12, v13
  v_add_f32 v117, v14, v15
  v_add_f32 v118, v16, v17
  v_add_f32 v119, v18, v19
  v_add_f32 v116, v116, v117
  v_add_f32 v118, v118, v119
  v_add_f32 v116, v116, v118
  s_nop 1
  v_add_f32_dpp v116, v116, v116 row_ror:8 row_mask:0xf bank_mask:0xf
  v_lshlrev_b32 v36, 16, v20
  v_and_b32 v37, 0xffff0000, v20
  v_add_f32_dpp v116, v116, v116 row_ror:4 row_mask:0xf bank_mask:0xf
  v_lshlrev_b32 v38, 16, v21
  v_and_b32 v39, 0xffff0000, v21
  v_add_f32_dpp v116, v116, v116 row_ror:2 row_mask:0xf bank_mask:0xf
  v_lshlrev_b32 v40, 16, v22
  v_and_b32 v41, 0xffff0000, v22
  v_add_f32_dpp v116, v116, v116 row_ror:1 row_mask:0xf bank_mask:0xf
  v_lshlrev_b32 v42, 16, v23
  v_and_b32 v43, 0xffff0000, v23
  v_mov_b32 v117, v116
  s_nop 1
  v_permlane16_swap_b32 v116, v117
  v_add_f32 v116, v116, v117
  v_mov_b32 v117, v116
  s_nop 1
  v_permlane32_swap_b32 v116, v117
  v_add_f32 v116, v116, v117
  v_mul_f32 v116, 0x3b000000, v116
  v_sub_f32 v12, v12, v116
  v_sub_f32 v13, v13, v116
  v_sub_f32 v14, v14, v116
  v_sub_f32 v15, v15, v116
  v_sub_f32 v16, v16, v116
  v_sub_f32 v17, v17, v116
  v_sub_f32 v18, v18, v116
  v_sub_f32 v19, v19, v116
  v_mul_f32 v118, v12, v12
  v_mul_f32 v119, v13, v13
  v_fmac_f32 v118, v14, v14
  v_fmac_f32 v119, v15, v15
  v_fmac_f32 v118, v16, v16
  v_fmac_f32 v119, v17, v17
  v_fmac_f32 v118, v18, v18
  v_fmac_f32 v119, v19, v19
  v_add_f32 v118, v118, v119
  v_cvt_pk_bf16_f32 v116, 0, v116
  s_nop 0
  v_add_f32_dpp v118, v118, v118 row_ror:8 row_mask:0xf bank_mask:0xf
  v_sub_f32 v36, v36, v116
  v_sub_f32 v37, v37, v116
  v_add_f32_dpp v118, v118, v118 row_ror:4 row_mask:0xf bank_mask:0xf
  v_sub_f32 v38, v38, v116
  v_sub_f32 v39, v39, v116
  v_add_f32_dpp v118, v118, v118 row_ror:2 row_mask:0xf bank_mask:0xf
  v_sub_f32 v40, v40, v116
  v_sub_f32 v41, v41, v116
  v_add_f32_dpp v118, v118, v118 row_ror:1 row_mask:0xf bank_mask:0xf
  v_sub_f32 v42, v42, v116
  v_sub_f32 v43, v43, v116
  v_mov_b32 v117, v118
  v_cvt_pk_bf16_f32 v36, 0, v36
  v_cvt_pk_bf16_f32 v37, 0, v37
  v_permlane16_swap_b32 v118, v117
  v_cvt_pk_bf16_f32 v38, 0, v38
  v_cvt_pk_bf16_f32 v39, 0, v39
  v_add_f32 v118, v118, v117
  v_cvt_pk_bf16_f32 v40, 0, v40
  v_cvt_pk_bf16_f32 v41, 0, v41
  v_mov_b32 v117, v118
  v_cvt_pk_bf16_f32 v42, 0, v42
  v_cvt_pk_bf16_f32 v43, 0, v43
  v_permlane32_swap_b32 v118, v117
  v_add_f32 v118, v118, v117
  v_mul_f32 v118, 0x3b000000, v118
  v_cvt_pk_bf16_f32 v118, 0, v118
  v_add_f32 v118, 0x3727c5ac, v118
  v_cvt_pk_bf16_f32 v118, 0, v118
  v_sqrt_f32 v118, v118
  s_nop 0
  v_cvt_pk_bf16_f32 v118, 0, v118
  v_rcp_f32 v119, v118
  s_nop 0
  v_mul_f32 v52, v36, v119
  v_mul_f32 v53, v37, v119
  v_mul_f32 v54, v38, v119
  v_mul_f32 v55, v39, v119
  v_mul_f32 v56, v40, v119
  v_mul_f32 v57, v41, v119
  v_mul_f32 v58, v42, v119
  v_mul_f32 v59, v43, v119
  v_fma_f32 v36, -v52, v118, v36
  v_fma_f32 v37, -v53, v118, v37
  v_fma_f32 v38, -v54, v118, v38
  v_fma_f32 v39, -v55, v118, v39
  v_fma_f32 v40, -v56, v118, v40
  v_fma_f32 v41, -v57, v118, v41
  v_fma_f32 v42, -v58, v118, v42
  v_fma_f32 v43, -v59, v118, v43
  v_fmac_f32 v52, v36, v119
  v_fmac_f32 v53, v37, v119
  v_fmac_f32 v54, v38, v119
  v_fmac_f32 v55, v39, v119
  v_fmac_f32 v56, v40, v119
  v_fmac_f32 v57, v41, v119
  v_fmac_f32 v58, v42, v119
  v_fmac_f32 v59, v43, v119
  v_cvt_pk_bf16_f32 v36, v52, 0
  v_cvt_pk_bf16_f32 v37, v53, 0
  v_cvt_pk_bf16_f32 v38, v54, 0
  v_cvt_pk_bf16_f32 v39, v55, 0
  v_cvt_pk_bf16_f32 v40, v56, 0
  v_cvt_pk_bf16_f32 v41, v57, 0
  v_cvt_pk_bf16_f32 v42, v58, 0
  v_cvt_pk_bf16_f32 v43, v59, 0
  v_cvt_pk_bf16_f32 v52, 0, v52
  v_cvt_pk_bf16_f32 v53, 0, v53
  v_cvt_pk_bf16_f32 v54, 0, v54
  v_cvt_pk_bf16_f32 v55, 0, v55
  v_cvt_pk_bf16_f32 v56, 0, v56
  v_cvt_pk_bf16_f32 v57, 0, v57
  v_cvt_pk_bf16_f32 v58, 0, v58
  v_cvt_pk_bf16_f32 v59, 0, v59
  s_waitcnt vmcnt(7)
  v_dot2c_f32_bf16 v28, v128, v36
  v_dot2c_f32_bf16 v29, v128, v52
  v_dot2c_f32_bf16 v30, v129, v36
  v_dot2c_f32_bf16 v31, v129, v52
  v_dot2c_f32_bf16 v32, v130, v36
  v_dot2c_f32_bf16 v33, v130, v52
  v_dot2c_f32_bf16 v34, v131, v36
  v_dot2c_f32_bf16 v35, v131, v52
  s_waitcnt vmcnt(6)
  v_dot2c_f32_bf16 v28, v132, v37
  v_dot2c_f32_bf16 v29, v132, v53
  v_dot2c_f32_bf16 v30, v133, v37
  v_dot2c_f32_bf16 v31, v133, v53
  v_dot2c_f32_bf16 v32, v134, v37
  v_dot2c_f32_bf16 v33, v134, v53
  v_dot2c_f32_bf16 v34, v135, v37
  v_dot2c_f32_bf16 v35, v135, v53
  s_waitcnt vmcnt(5)
  v_dot2c_f32_bf16 v28, v136, v38
  v_dot2c_f32_bf16 v29, v136, v54
  v_dot2c_f32_bf16 v30, v137, v38
  v_dot2c_f32_bf16 v31, v137, v54
  v_dot2c_f32_bf16 v32, v138, v38
  v_dot2c_f32_bf16 v33, v138, v54
  v_dot2c_f32_bf16 v34, v139, v38
  v_dot2c_f32_bf16 v35, v139, v54
  s_waitcnt vmcnt(4)
  v_dot2c_f32_bf16 v28, v140, v39
  v_dot2c_f32_bf16 v29, v140, v55
  v_dot2c_f32_bf16 v30, v141, v39
  v_dot2c_f32_bf16 v31, v141, v55
  v_dot2c_f32_bf16 v32, v142, v39
  v_dot2c_f32_bf16 v33, v142, v55
  v_dot2c_f32_bf16 v34, v143, v39
  v_dot2c_f32_bf16 v35, v143, v55
  s_waitcnt vmcnt(3)
  v_dot2c_f32_bf16 v28, v144, v40
  v_dot2c_f32_bf16 v29, v144, v56
  v_dot2c_f32_bf16 v30, v145, v40
  v_dot2c_f32_bf16 v31, v145, v56
  v_dot2c_f32_bf16 v32, v146, v40
  v_dot2c_f32_bf16 v33, v146, v56
  v_dot2c_f32_bf16 v34, v147, v40
  v_dot2c_f32_bf16 v35, v147, v56
  s_waitcnt vmcnt(2)
  v_dot2c_f32_bf16 v28, v148, v41
  v_dot2c_f32_bf16 v29, v148, v57
  v_dot2c_f32_bf16 v30, v149, v41
  v_dot2c_f32_bf16 v31, v149, v57
  v_dot2c_f32_bf16 v32, v150, v41
  v_dot2c_f32_bf16 v33, v150, v57
  v_dot2c_f32_bf16 v34, v151, v41
  v_dot2c_f32_bf16 v35, v151, v57
  s_waitcnt vmcnt(1)
  v_dot2c_f32_bf16 v28, v152, v42
  v_dot2c_f32_bf16 v29, v152, v58
  v_dot2c_f32_bf16 v30, v153, v42
  v_dot2c_f32_bf16 v31, v153, v58
  v_dot2c_f32_bf16 v32, v154, v42
  v_dot2c_f32_bf16 v33, v154, v58
  v_dot2c_f32_bf16 v34, v155, v42
  v_dot2c_f32_bf16 v35, v155, v58
  s_waitcnt vmcnt(0)
  v_dot2c_f32_bf16 v28, v156, v43
  v_dot2c_f32_bf16 v29, v156, v59
  v_dot2c_f32_bf16 v30, v157, v43
  v_dot2c_f32_bf16 v31, v157, v59
  v_dot2c_f32_bf16 v32, v158, v43
  v_dot2c_f32_bf16 v33, v158, v59
  v_dot2c_f32_bf16 v34, v159, v43
  v_dot2c_f32_bf16 v35, v159, v59
  v_permlane32_swap_b32 v28, v32
  v_permlane32_swap_b32 v29, v33
  v_permlane32_swap_b32 v30, v34
  v_permlane32_swap_b32 v31, v35
  v_add_f32 v28, v28, v32
  v_add_f32 v29, v29, v33
  v_add_f32 v30, v30, v34
  v_add_f32 v31, v31, v35
  v_add_f32_dpp v28, v28, v28 row_ror:8 row_mask:0xf bank_mask:0xf
  v_add_f32_dpp v29, v29, v29 row_ror:8 row_mask:0xf bank_mask:0xf
  v_add_f32_dpp v30, v30, v30 row_ror:8 row_mask:0xf bank_mask:0xf
  v_add_f32_dpp v31, v31, v31 row_ror:8 row_mask:0xf bank_mask:0xf
  v_mov_b32 v32, v28
  v_mov_b32 v33, v29
  v_mov_b32 v34, v30
  v_mov_b32 v35, v31
  v_permlane16_swap_b32 v28, v32
  v_permlane16_swap_b32 v29, v33
  v_permlane16_swap_b32 v30, v34
  v_permlane16_swap_b32 v31, v35
  v_add_f32 v28, v28, v32
  v_add_f32 v29, v29, v33
  v_add_f32 v30, v30, v34
  v_add_f32 v31, v31, v35
  s_waitcnt lgkmcnt(0)
  s_mul_i32 s39, s38, 1664525
  s_add_u32 s39, s39, 1013904223
  s_lshr_b32 s81, s39, 8
  s_lshr_b32 s82, s39, 16
  s_lshr_b32 s83, s39, 24
  v_bfi_b32 v28, v206, s39, v28
  v_bfi_b32 v29, v206, s81, v29
  v_bfi_b32 v30, v206, s82, v30
  v_bfi_b32 v31, v206, s83, v31
  s_mov_b32 exec_lo, 0xff
  s_mov_b32 exec_hi, 0xff
  global_store_dwordx4 v122, v[28:31], s[36:37] sc1
  s_mov_b64 exec, -1
  s_lshl_b32 s10, s9, 16
  s_lshl_b32 s11, s8, 7
  s_add_u32 s10, s10, s11
  v_lshlrev_b32 v120, 13, v7
  v_lshl_add_u32 v120, v202, 4, v120
  v_add_u32 v120, s10, v120
  v_add_u32 v121, 4096, v120
  s_lshl_b32 s10, s9, 11
  s_add_u32 s10, s10, 69632
  v_lshlrev_b32 v122, 8, v202
  v_lshl_add_u32 v122, v7, 4, v122
  v_add_u32 v122, s10, v122
  s_lshl_b32 s10, s8, 13
  s_lshl_b32 s11, s9, 6
  s_add_u32 s10, s10, s11
  s_add_u32 s10, s10, 131072
  v_lshrrev_b32 v123, 1, v202
  v_lshlrev_b32 v123, 11, v123
  v_and_b32 v125, 1, v0
  v_lshl_add_u32 v123, v125, 5, v123
  v_lshl_add_u32 v123, v124, 4, v123
  v_add_u32 v123, s10, v123
  v_mov_b32 v126, 0
  s_mov_b32 s12, 1048576
L_fw_h:
  ds_read_b32 v127, v126 offset:9984
  s_sub_u32 s12, s12, 1
  s_cmp_eq_u32 s12, 0
  s_waitcnt lgkmcnt(0)
  s_cbranch_scc1 L_fw_h_ok
  v_cmp_gt_u32 vcc, 1, v127
  s_cbranch_vccz L_fw_h_ok
  s_sleep 8
  s_branch L_fw_h
L_fw_h_ok:
  global_load_dwordx4 v[128:131], v120, s[30:31] offset:0 nt
  global_load_dwordx4 v[132:135], v120, s[30:31] offset:1024 nt
  global_load_dwordx4 v[136:139], v120, s[30:31] offset:2048 nt
  global_load_dwordx4 v[140:143], v120, s[30:31] offset:3072 nt
  global_load_dwordx4 v[144:147], v121, s[30:31] offset:0 nt
  global_load_dwordx4 v[148:151], v121, s[30:31] offset:1024 nt
  global_load_dwordx4 v[152:155], v121, s[30:31] offset:2048 nt
  global_load_dwordx4 v[156:159], v121, s[30:31] offset:3072 nt
  v_mov_b32 v28, 0
  v_mov_b32 v29, 0
  v_mov_b32 v30, 0
  v_mov_b32 v31, 0
  v_mov_b32 v32, 0
  v_mov_b32 v33, 0
  v_mov_b32 v34, 0
  v_mov_b32 v35, 0
  s_mov_b32 s12, 65536
L_hpoll:
  global_load_dwordx4 v[8:11], v122, s[36:37] sc1
  global_load_dwordx4 v[12:15], v122, s[36:37] offset:128 sc1
  s_waitcnt vmcnt(0)
  v_xor_b32 v16, s39, v8
  v_bitop3_b32 v16, v16, v9, s81 bitop3:0xf6
  v_bitop3_b32 v16, v16, v10, s82 bitop3:0xf6
  v_bitop3_b32 v16, v16, v11, s83 bitop3:0xf6
  v_bitop3_b32 v16, v16, v12, s39 bitop3:0xf6
  v_bitop3_b32 v16, v16, v13, s81 bitop3:0xf6
  v_bitop3_b32 v16, v16, v14, s82 bitop3:0xf6
  v_bitop3_b32 v16, v16, v15, s83 bitop3:0xf6
  v_and_b32 v16, 0xff, v16
  s_sub_u32 s12, s12, 1
  v_cmp_ne_u32 vcc, 0, v16
  s_cbranch_scc1 L_hok
  s_cbranch_vccz L_hok
  s_sleep 16
  s_branch L_hpoll
L_hok:
  v_add_f32_dpp v8, v8, v8 quad_perm:[1,0,3,2] row_mask:0xf bank_mask:0xf
  v_add_f32_dpp v9, v9, v9 quad_perm:[1,0,3,2] row_mask:0xf bank_mask:0xf
  v_add_f32_dpp v10, v10, v10 quad_perm:[1,0,3,2] row_mask:0xf bank_mask:0xf
  v_add_f32_dpp v11, v11, v11 quad_perm:[1,0,3,2] row_mask:0xf bank_mask:0xf
  v_add_f32_dpp v12, v12, v12 quad_perm:[1,0,3,2] row_mask:0xf bank_mask:0xf
  v_add_f32_dpp v13, v13, v13 quad_perm:[1,0,3,2] row_mask:0xf bank_mask:0xf
  v_add_f32_dpp v14, v14, v14 quad_perm:[1,0,3,2] row_mask:0xf bank_mask:0xf
  v_add_f32_dpp v15, v15, v15 quad_perm:[1,0,3,2] row_mask:0xf bank_mask:0xf
  v_add_f32_dpp v8, v8, v8 quad_perm:[2,3,0,1] row_mask:0xf bank_mask:0xf
  v_add_f32_dpp v9, v9, v9 quad_perm:[2,3,0,1] row_mask:0xf bank_mask:0xf
  v_add_f32_dpp v10, v10, v10 quad_perm:[2,3,0,1] row_mask:0xf bank_mask:0xf
  v_add_f32_dpp v11, v11, v11 quad_perm:[2,3,0,1] row_mask:0xf bank_mask:0xf
  v_add_f32_dpp v12, v12, v12 quad_perm:[2,3,0,1] row_mask:0xf bank_mask:0xf
  v_add_f32_dpp v13, v13, v13 quad_perm:[2,3,0,1] row_mask:0xf bank_mask:0xf
  v_add_f32_dpp v14, v14, v14 quad_perm:[2,3,0,1] row_mask:0xf bank_mask:0xf
  v_add_f32_dpp v15, v15, v15 quad_perm:[2,3,0,1] row_mask:0xf bank_mask:0xf
  v_add_f32_dpp v8, v8, v8 row_half_mirror row_mask:0xf bank_mask:0xf
  v_add_f32_dpp v9, v9, v9 row_half_mirror row_mask:0xf bank_mask:0xf
  v_add_f32_dpp v10, v10, v10 row_half_mirror row_mask:0xf bank_mask:0xf
  v_add_f32_dpp v11, v11, v11 row_half_mirror row_mask:0xf bank_mask:0xf
  v_add_f32_dpp v12, v12, v12 row_half_mirror row_mask:0xf bank_mask:0xf
  v_add_f32_dpp v13, v13, v13 row_half_mirror row_mask:0xf bank_mask:0xf
  v_add_f32_dpp v14, v14, v14 row_half_mirror row_mask:0xf bank_mask:0xf
  v_add_f32_dpp v15, v15, v15 row_half_mirror row_mask:0xf bank_mask:0xf
  v_max_f32 v8, 0, v8
  v_max_f32 v9, 0, v9
  v_max_f32 v10, 0, v10
  v_max_f32 v11, 0, v11
  v_max_f32 v12, 0, v12
  v_max_f32 v13, 0, v13
  v_max_f32 v14, 0, v14
  v_max_f32 v15, 0, v15
  v_cvt_pk_bf16_f32 v36, v8, 0
  v_cvt_pk_bf16_f32 v37, v9, 0
  v_cvt_pk_bf16_f32 v38, v10, 0
  v_cvt_pk_bf16_f32 v39, v11, 0
  v_cvt_pk_bf16_f32 v40, v12, 0
  v_cvt_pk_bf16_f32 v41, v13, 0
  v_cvt_pk_bf16_f32 v42, v14, 0
  v_cvt_pk_bf16_f32 v43, v15, 0
  v_cvt_pk_bf16_f32 v52, 0, v8
  v_cvt_pk_bf16_f32 v53, 0, v9
  v_cvt_pk_bf16_f32 v54, 0, v10
  v_cvt_pk_bf16_f32 v55, 0, v11
  v_cvt_pk_bf16_f32 v56, 0, v12
  v_cvt_pk_bf16_f32 v57, 0, v13
  v_cvt_pk_bf16_f32 v58, 0, v14
  v_cvt_pk_bf16_f32 v59, 0, v15
  v_dot2c_f32_bf16 v28, v128, v36
  v_dot2c_f32_bf16 v29, v128, v52
  v_dot2c_f32_bf16 v30, v129, v36
  v_dot2c_f32_bf16 v31, v129, v52
  v_dot2c_f32_bf16 v32, v130, v36
  v_dot2c_f32_bf16 v33, v130, v52
  v_dot2c_f32_bf16 v34, v131, v36
  v_dot2c_f32_bf16 v35, v131, v52
  v_dot2c_f32_bf16 v28, v132, v37
  v_dot2c_f32_bf16 v29, v132, v53
  v_dot2c_f32_bf16 v30, v133, v37
  v_dot2c_f32_bf16 v31, v133, v53
  v_dot2c_f32_bf16 v32, v134, v37
  v_dot2c_f32_bf16 v33, v134, v53
  v_dot2c_f32_bf16 v34, v135, v37
  v_dot2c_f32_bf16 v35, v135, v53
  v_dot2c_f32_bf16 v28, v136, v38
  v_dot2c_f32_bf16 v29, v136, v54
  v_dot2c_f32_bf16 v30, v137, v38
  v_dot2c_f32_bf16 v31, v137, v54
  v_dot2c_f32_bf16 v32, v138, v38
  v_dot2c_f32_bf16 v33, v138, v54
  v_dot2c_f32_bf16 v34, v139, v38
  v_dot2c_f32_bf16 v35, v139, v54
  v_dot2c_f32_bf16 v28, v140, v39
  v_dot2c_f32_bf16 v29, v140, v55
  v_dot2c_f32_bf16 v30, v141, v39
  v_dot2c_f32_bf16 v31, v141, v55
  v_dot2c_f32_bf16 v32, v142, v39
  v_dot2c_f32_bf16 v33, v142, v55
  v_dot2c_f32_bf16 v34, v143, v39
  v_dot2c_f32_bf16 v35, v143, v55
  v_dot2c_f32_bf16 v28, v144, v40
  v_dot2c_f32_bf16 v29, v144, v56
  v_dot2c_f32_bf16 v30, v145, v40
  v_dot2c_f32_bf16 v31, v145, v56
  v_dot2c_f32_bf16 v32, v146, v40
  v_dot2c_f32_bf16 v33, v146, v56
  v_dot2c_f32_bf16 v34, v147, v40
  v_dot2c_f32_bf16 v35, v147, v56
  v_dot2c_f32_bf16 v28, v148, v41
  v_dot2c_f32_bf16 v29, v148, v57
  v_dot2c_f32_bf16 v30, v149, v41
  v_dot2c_f32_bf16 v31, v149, v57
  v_dot2c_f32_bf16 v32, v150, v41
  v_dot2c_f32_bf16 v33, v150, v57
  v_dot2c_f32_bf16 v34, v151, v41
  v_dot2c_f32_bf16 v35, v151, v57
  v_dot2c_f32_bf16 v28, v152, v42
  v_dot2c_f32_bf16 v29, v152, v58
  v_dot2c_f32_bf16 v30, v153, v42
  v_dot2c_f32_bf16 v31, v153, v58
  v_dot2c_f32_bf16 v32, v154, v42
  v_dot2c_f32_bf16 v33, v154, v58
  v_dot2c_f32_bf16 v34, v155, v42
  v_dot2c_f32_bf16 v35, v155, v58
  v_dot2c_f32_bf16 v28, v156, v43
  v_dot2c_f32_bf16 v29, v156, v59
  v_dot2c_f32_bf16 v30, v157, v43
  v_dot2c_f32_bf16 v31, v157, v59
  v_dot2c_f32_bf16 v32, v158, v43
  v_dot2c_f32_bf16 v33, v158, v59
  v_dot2c_f32_bf16 v34, v159, v43
  v_dot2c_f32_bf16 v35, v159, v59
  v_permlane32_swap_b32 v28, v32
  v_permlane32_swap_b32 v29, v33
  v_permlane32_swap_b32 v30, v34
  v_permlane32_swap_b32 v31, v35
  v_add_f32 v28, v28, v32
  v_add_f32 v29, v29, v33
  v_add_f32 v30, v30, v34
  v_add_f32 v31, v31, v35
  v_add_f32_dpp v28, v28, v28 row_ror:8 row_mask:0xf bank_mask:0xf
  v_add_f32_dpp v29, v29, v29 row_ror:8 row_mask:0xf bank_mask:0xf
  v_add_f32_dpp v30, v30, v30 row_ror:8 row_mask:0xf bank_mask:0xf
  v_add_f32_dpp v31, v31, v31 row_ror:8 row_mask:0xf bank_mask:0xf
  v_mov_b32 v32, v28
  v_mov_b32 v33, v29
  v_mov_b32 v34, v30
  v_mov_b32 v35, v31
  v_permlane16_swap_b32 v28, v32
  v_permlane16_swap_b32 v29, v33
  v_permlane16_swap_b32 v30, v34
  v_permlane16_swap_b32 v31, v35
  v_add_f32 v28, v28, v32
  v_add_f32 v29, v29, v33
  v_add_f32 v30, v30, v34
  v_add_f32 v31, v31, v35
  v_bfi_b32 v28, v206, s39, v28
  v_bfi_b32 v29, v206, s81, v29
  v_bfi_b32 v30, v206, s82, v30
  v_bfi_b32 v31, v206, s83, v31
  s_mov_b32 exec_lo, 0xff
  s_mov_b32 exec_hi, 0xff
  global_store_dwordx4 v123, v[28:31], s[36:37] sc1
  s_mov_b64 exec, -1
  s_endpgm
L_fin:
  s_lshl_b32 s13, s4, 2
  s_add_u32 s13, s13, s5
  v_and_b32 v120, 3, v0
  v_lshl_add_u32 v120, v120, 2, v5
  s_lshl_b32 s10, s13, 4
  v_add_lshl_u32 v120, v120, s10, 1
  s_lshl_b32 s10, s13, 11
  s_add_u32 s10, s10, 131072
  v_add_u32 v121, s10, v6
  s_lshl_b32 s10, s13, 12
  s_add_u32 s10, s10, 262144
  v_add_u32 v122, s10, v6
  v_mov_b32 v60, 0
  v_mov_b32 v197, 0
  s_waitcnt lgkmcnt(0)
  s_load_dword s38, s[36:37], 0
  s_barrier
  global_load_short_d16_hi v60, v120, s[16:17]
  s_waitcnt lgkmcnt(0)
  s_mul_i32 s39, s38, 1664525
  s_add_u32 s39, s39, 1013904223
  s_lshr_b32 s81, s39, 8
  s_lshr_b32 s82, s39, 16
  s_lshr_b32 s83, s39, 24
  v_and_b32 v12, s39, v206
  v_and_b32 v13, s81, v206
  v_and_b32 v14, s82, v206
  v_and_b32 v15, s83, v206
  v_mov_b32 v126, 0
  s_mov_b32 s12, 1048576
L_fw_f:
  ds_read_b32 v127, v126 offset:9984
  s_sub_u32 s12, s12, 1
  s_cmp_eq_u32 s12, 0
  s_waitcnt lgkmcnt(0)
  s_cbranch_scc1 L_fw_f_ok
  v_cmp_gt_u32 vcc, 1, v127
  s_cbranch_vccz L_fw_f_ok
  s_sleep 8
  s_branch L_fw_f
L_fw_f_ok:
  s_mov_b32 s12, 65536
L_gpoll:
  s_sleep 64
  global_load_dwordx4 v[8:11], v121, s[36:37] sc1
  s_mov_b32 exec_hi, 0xffff
  global_load_dwordx4 v[12:15], v121, s[36:37] offset:1024 sc1
  s_mov_b32 exec_hi, -1
  s_waitcnt vmcnt(0)
  v_xor_b32 v16, s39, v8
  v_bitop3_b32 v16, v16, v9, s81 bitop3:0xf6
  v_bitop3_b32 v16, v16, v10, s82 bitop3:0xf6
  v_bitop3_b32 v16, v16, v11, s83 bitop3:0xf6
  v_bitop3_b32 v16, v16, v12, s39 bitop3:0xf6
  v_bitop3_b32 v16, v16, v13, s81 bitop3:0xf6
  v_bitop3_b32 v16, v16, v14, s82 bitop3:0xf6
  v_bitop3_b32 v16, v16, v15, s83 bitop3:0xf6
  v_and_b32 v16, 0xff, v16
  s_sub_u32 s12, s12, 1
  v_cmp_ne_u32 vcc, 0, v16
  s_cbranch_scc1 L_gok
  s_cbranch_vccnz L_gpoll
L_gok:
  v_pk_add_f32 v[8:9], v[8:9], v[12:13]
  v_pk_add_f32 v[10:11], v[10:11], v[14:15]
  s_nop 1
  v_permlane32_swap_b32 v8, v10
  v_permlane32_swap_b32 v9, v11
  v_add_f32 v8, v8, v10
  v_add_f32 v9, v9, v11
  s_nop 1
  v_permlane16_swap_b32 v8, v9
  v_add_f32 v8, v8, v9
  s_nop 1
  v_add_f32_dpp v8, v8, v8 row_ror:8 row_mask:0xf bank_mask:0xf
  s_nop 1
  v_add_f32_dpp v8, v8, v8 row_ror:4 row_mask:0xf bank_mask:0xf
  v_cvt_pk_bf16_f32 v8, 0, v8
  v_mul_f32 v9, 0xbfb8aa3b, v8
  v_exp_f32 v9, v9
  s_nop 0
  v_add_f32 v9, 1.0, v9
  v_rcp_f32 v9, v9
  s_nop 0
  v_mul_f32 v9, v8, v9
  v_cvt_pk_bf16_f32 v56, 0, v9
  v_mov_b32 v126, 0
  s_mov_b32 s12, 1048576
L_fw_d:
  ds_read_b32 v127, v126 offset:9984
  s_sub_u32 s12, s12, 1
  s_cmp_eq_u32 s12, 0
  s_waitcnt lgkmcnt(0)
  s_cbranch_scc1 L_fw_d_ok
  v_cmp_gt_u32 vcc, 2, v127
  s_cbranch_vccz L_fw_d_ok
  s_sleep 2
  s_branch L_fw_d
L_fw_d_ok:
  s_mov_b32 s12, 65536
L_h2poll:
  global_load_dwordx4 v[128:131], v122, s[36:37] offset:0 sc1
  global_load_dwordx4 v[132:135], v122, s[36:37] offset:1024 sc1
  global_load_dwordx4 v[136:139], v122, s[36:37] offset:2048 sc1
  global_load_dwordx4 v[140:143], v122, s[36:37] offset:3072 sc1
  s_waitcnt vmcnt(2)
  v_xor_b32 v16, s39, v128
  v_bitop3_b32 v16, v16, v129, s81 bitop3:0xf6
  v_bitop3_b32 v16, v16, v130, s82 bitop3:0xf6
  v_bitop3_b32 v16, v16, v131, s83 bitop3:0xf6
  v_xor_b32 v17, s39, v132
  v_bitop3_b32 v17, v17, v133, s81 bitop3:0xf6
  v_bitop3_b32 v17, v17, v134, s82 bitop3:0xf6
  v_bitop3_b32 v17, v17, v135, s83 bitop3:0xf6
  v_pk_add_f32 v[8:9], v[128:129], v[132:133]
  v_pk_add_f32 v[10:11], v[130:131], v[134:135]
  s_waitcnt vmcnt(0)
  v_pk_add_f32 v[12:13], v[136:137], v[140:141]
  v_pk_add_f32 v[14:15], v[138:139], v[142:143]
  v_pk_add_f32 v[8:9], v[8:9], v[12:13]
  v_pk_add_f32 v[10:11], v[10:11], v[14:15]
  s_nop 1
  v_permlane32_swap_b32 v8, v10
  v_bitop3_b32 v16, v16, v136, s39 bitop3:0xf6
  v_permlane32_swap_b32 v9, v11
  v_bitop3_b32 v16, v16, v137, s81 bitop3:0xf6
  v_add_f32 v8, v8, v10
  v_bitop3_b32 v16, v16, v138, s82 bitop3:0xf6
  v_add_f32 v9, v9, v11
  v_bitop3_b32 v16, v16, v139, s83 bitop3:0xf6
  s_nop 0
  v_permlane16_swap_b32 v8, v9
  v_bitop3_b32 v17, v17, v140, s39 bitop3:0xf6
  v_add_f32 v8, v8, v9
  v_bitop3_b32 v17, v17, v141, s81 bitop3:0xf6
  s_nop 0
  v_add_f32_dpp v8, v8, v8 row_ror:8 row_mask:0xf bank_mask:0xf
  v_bitop3_b32 v17, v17, v142, s82 bitop3:0xf6
  s_nop 0
  v_add_f32_dpp v8, v8, v8 row_ror:4 row_mask:0xf bank_mask:0xf
  v_bitop3_b32 v17, v17, v143, s83 bitop3:0xf6
  v_cvt_pk_bf16_f32 v8, 0, v8
  v_or_b32 v16, v16, v17
  v_mul_f32 v8, v8, v56
  v_cvt_pk_bf16_f32 v8, 0, v8
  v_add_f32 v8, v8, v60
  v_cvt_pk_bf16_f32 v8, v8, v8
  v_and_b32 v16, 0xff, v16
  s_sub_u32 s12, s12, 1
  v_cmp_ne_u32 vcc, 0, v16
  s_cbranch_scc1 L_h2ok
  s_cbranch_vccnz L_h2poll
L_h2ok:
  s_mov_b32 exec_lo, 0x000f000f
  s_mov_b32 exec_hi, 0x000f000f
  global_store_short v120, v8, s[32:33] sc0 sc1
  s_cmp_lg_u32 s2, 0
  s_cbranch_scc1 L_fin_end
  s_mov_b64 exec, 1
  v_mov_b32 v134, s39
  global_store_dword v197, v134, s[36:37] sc1
L_fin_end:
  s_endpgm
L_stream:
  v_lshrrev_b32 v30, 2, v4
  v_lshlrev_b32 v30, 8, v30
  v_lshl_add_u32 v30, v6, 4, v30
  s_mov_b32 s84, 0xaaaaaaaa
  s_mov_b32 s85, 0xaaaaaaaa
  s_mov_b32 s96, 0x22222222
  s_mov_b32 s97, 0x22222222
  s_mov_b32 s98, 0x44444444
  s_mov_b32 s99, 0x44444444
  s_mov_b32 s100, 0x88888888
  s_mov_b32 s101, 0x88888888
  v_and_b32 v28, 1, v0
  v_lshlrev_b32 v28, 4, v28
  v_mov_b32 v29, 0xffff
  v_lshlrev_b32 v28, v28, v29
  v_and_b32 v29, 2, v0
  v_cmp_eq_u32 vcc, 0, v29
  s_nop 1
  v_cndmask_b32 v26, 0, v28, vcc
  v_cndmask_b32 v27, v28, 0, vcc
  s_mov_b32 s9, 0x3e0293ee
  s_waitcnt vmcnt(4)
  buffer_load_dwordx4 v[84:87], v1, s[40:43], s7 offen offset:128 nt
  s_waitcnt vmcnt(4)
  buffer_load_dwordx4 v[88:91], v1, s[40:43], s7 offen offset:512 nt
  s_waitcnt vmcnt(4)
  buffer_load_dwordx4 v[92:95], v1, s[40:43], s7 offen offset:640 nt
  s_waitcnt vmcnt(4)
  s_add_u32 s7, s7, 32768
  buffer_load_dwordx4 v[96:99], v1, s[40:43], s7 offen offset:0 nt
  s_waitcnt vmcnt(4)
  buffer_load_dwordx4 v[100:103], v1, s[40:43], s7 offen offset:128 nt
  s_waitcnt vmcnt(4)
  buffer_load_dwordx4 v[104:107], v1, s[40:43], s7 offen offset:512 nt
  s_waitcnt vmcnt(4)
  buffer_load_dwordx4 v[108:111], v1, s[40:43], s7 offen offset:640 nt
  s_waitcnt vmcnt(4)
  s_add_u32 s7, s7, 32768
  buffer_load_dwordx4 v[112:115], v1, s[40:43], s7 offen offset:0 nt
  s_waitcnt vmcnt(4)
  buffer_load_dwordx4 v[116:119], v1, s[40:43], s7 offen offset:128 nt
  s_waitcnt vmcnt(4)
  buffer_load_dwordx4 v[120:123], v1, s[40:43], s7 offen offset:512 nt
  s_waitcnt vmcnt(4)
  buffer_load_dwordx4 v[124:127], v1, s[40:43], s7 offen offset:640 nt
  s_waitcnt vmcnt(4)
  s_add_u32 s7, s7, 32768
  buffer_load_dwordx4 v[128:131], v1, s[40:43], s7 offen offset:0 nt
  s_waitcnt vmcnt(4)
  buffer_load_dwordx4 v[132:135], v1, s[40:43], s7 offen offset:128 nt
  s_waitcnt vmcnt(4)
  buffer_load_dwordx4 v[136:139], v1, s[40:43], s7 offen offset:512 nt
  s_waitcnt vmcnt(4)
  buffer_load_dwordx4 v[140:143], v1, s[40:43], s7 offen offset:640 nt
  s_waitcnt vmcnt(4)
  s_add_u32 s7, s7, 32768
  buffer_load_dwordx4 v[144:147], v1, s[40:43], s7 offen offset:0 nt
  s_waitcnt vmcnt(4)
  buffer_load_dwordx4 v[148:151], v1, s[40:43], s7 offen offset:128 nt
  s_waitcnt vmcnt(4)
  buffer_load_dwordx4 v[152:155], v1, s[40:43], s7 offen offset:512 nt
  s_waitcnt vmcnt(4)
  buffer_load_dwordx4 v[156:159], v1, s[40:43], s7 offen offset:640 nt
  s_waitcnt vmcnt(4)
  s_add_u32 s7, s7, 32768
  buffer_load_dwordx4 v[160:163], v1, s[40:43], s7 offen offset:0 nt
  s_waitcnt vmcnt(4)
  buffer_load_dwordx4 v[164:167], v1, s[40:43], s7 offen offset:128 nt
  s_waitcnt vmcnt(4)
  buffer_load_dwordx4 v[168:171], v1, s[40:43], s7 offen offset:512 nt
  s_waitcnt vmcnt(4)
  buffer_load_dwordx4 v[172:175], v1, s[40:43], s7 offen offset:640 nt
  s_waitcnt vmcnt(4)
  s_add_u32 s7, s7, 32768
  buffer_load_dwordx4 v[176:179], v1, s[40:43], s7 offen offset:0 nt
  s_waitcnt vmcnt(4)
  buffer_load_dwordx4 v[180:183], v1, s[40:43], s7 offen offset:128 nt
  s_waitcnt vmcnt(4)
  buffer_load_dwordx4 v[184:187], v1, s[40:43], s7 offen offset:512 nt
  s_waitcnt vmcnt(4)
  buffer_load_dwordx4 v[188:191], v1, s[40:43], s7 offen offset:640 nt
  s_waitcnt vmcnt(4)
  s_add_u32 s7, s7, 32768
  buffer_load_dwordx4 v[192:195], v1, s[40:43], s7 offen offset:0 nt
  s_waitcnt vmcnt(4)
  buffer_load_dwordx4 v[196:199], v1, s[40:43], s7 offen offset:128 nt
  s_waitcnt vmcnt(4)
  buffer_load_dwordx4 v[200:203], v1, s[40:43], s7 offen offset:512 nt
  s_waitcnt vmcnt(4)
  buffer_load_dwordx4 v[204:207], v1, s[40:43], s7 offen offset:640 nt
  s_waitcnt vmcnt(4)
  s_add_u32 s7, s7, 32768
  buffer_load_dwordx4 v[208:211], v1, s[40:43], s7 offen offset:0 nt
  s_waitcnt vmcnt(4)
  buffer_load_dwordx4 v[212:215], v1, s[40:43], s7 offen offset:128 nt
  s_waitcnt vmcnt(4)
  buffer_load_dwordx4 v[216:219], v1, s[40:43], s7 offen offset:512 nt
  s_waitcnt vmcnt(4)
  buffer_load_dwordx4 v[220:223], v1, s[40:43], s7 offen offset:640 nt
  s_waitcnt vmcnt(4)
  s_add_u32 s7, s7, 32768
  buffer_load_dwordx4 v[224:227], v1, s[40:43], s7 offen offset:0 nt
  s_waitcnt vmcnt(4)
  buffer_load_dwordx4 v[228:231], v1, s[40:43], s7 offen offset:128 nt
  s_waitcnt vmcnt(4)
  buffer_load_dwordx4 v[232:235], v1, s[40:43], s7 offen offset:512 nt
  s_waitcnt vmcnt(4)
  buffer_load_dwordx4 v[236:239], v1, s[40:43], s7 offen offset:640 nt
  s_waitcnt vmcnt(4)
  s_add_u32 s7, s7, 32768
  buffer_load_dwordx4 v[240:243], v1, s[40:43], s7 offen offset:0 nt
  s_waitcnt vmcnt(4)
  buffer_load_dwordx4 v[244:247], v1, s[40:43], s7 offen offset:128 nt
  s_waitcnt vmcnt(4)
  buffer_load_dwordx4 v[248:251], v1, s[40:43], s7 offen offset:512 nt
  s_waitcnt vmcnt(4)
  buffer_load_dwordx4 v[252:255], v1, s[40:43], s7 offen offset:640 nt
  v_mov_b32 v28, 0
  s_mov_b32 s12, 1048576
L_fw_s:
  ds_read_b32 v29, v28 offset:9984
  s_sub_u32 s12, s12, 1
  s_cmp_eq_u32 s12, 0
  s_waitcnt lgkmcnt(0)
  s_cbranch_scc1 L_fw_s_ok
  v_cmp_gt_u32 vcc, 1, v29
  s_cbranch_vccz L_fw_s_ok
  s_sleep 1
  s_branch L_fw_s
L_fw_s_ok:
  ds_read_b128 v[4:7], v30 offset:0
  ds_read_b128 v[8:11], v30 offset:128
  s_mul_i32 s39, s38, 1664525
  s_add_u32 s39, s39, 1013904223
  s_lshr_b32 s81, s39, 8
  s_lshr_b32 s82, s39, 16
  s_lshr_b32 s83, s39, 24
  s_waitcnt lgkmcnt(0)
  v_mov_b32 v3, 0
  v_mov_b32 v30, 1
  s_mov_b64 vcc, 0
  v_mfma_f32_16x16x32_bf16 v[12:15], v[64:67], v[4:7], 0
  v_mfma_f32_16x16x32_bf16 v[12:15], v[68:71], v[8:11], v[12:15]
  v_mfma_f32_16x16x32_bf16 v[16:19], v[72:75], v[4:7], 0
  s_waitcnt vmcnt(4)
  s_add_u32 s7, s7, 32768
  buffer_load_dwordx4 v[64:67], v1, s[40:43], s7 offen offset:0 nt
  v_mfma_f32_16x16x32_bf16 v[16:19], v[76:79], v[8:11], v[16:19]
  s_nop 2
  v_cndmask_b32 v20, v12, v13, s[84:85]
  v_cndmask_b32 v21, v14, v15, s[84:85]
  s_nop 2
  v_cndmask_b32 v22, v16, v17, s[84:85]
  v_cndmask_b32 v23, v18, v19, s[84:85]
  v_add_f32_dpp v32, v20, v20 quad_perm:[1,0,3,2] row_mask:0xf bank_mask:0xf
  v_add_f32_dpp v33, v21, v21 quad_perm:[1,0,3,2] row_mask:0xf bank_mask:0xf
  v_add_f32_dpp v34, v22, v22 quad_perm:[1,0,3,2] row_mask:0xf bank_mask:0xf
  v_add_f32_dpp v35, v23, v23 quad_perm:[1,0,3,2] row_mask:0xf bank_mask:0xf
  v_mfma_f32_16x16x32_bf16 v[12:15], v[80:83], v[4:7], 0
  v_mfma_f32_16x16x32_bf16 v[12:15], v[84:87], v[8:11], v[12:15]
  s_waitcnt vmcnt(4)
  buffer_load_dwordx4 v[68:71], v1, s[40:43], s7 offen offset:128 nt
  v_mfma_f32_16x16x32_bf16 v[16:19], v[88:91], v[4:7], 0
  v_mfma_f32_16x16x32_bf16 v[16:19], v[92:95], v[8:11], v[16:19]
  s_nop 3
  v_cndmask_b32 v20, v12, v13, s[84:85]
  v_cndmask_b32 v21, v14, v15, s[84:85]
  s_nop 1
  v_cndmask_b32 v22, v16, v17, s[84:85]
  v_cndmask_b32 v23, v18, v19, s[84:85]
  v_add_f32_dpp v20, v20, v20 quad_perm:[1,0,3,2] row_mask:0xf bank_mask:0xf
  v_add_f32_dpp v21, v21, v21 quad_perm:[1,0,3,2] row_mask:0xf bank_mask:0xf
  v_add_f32_dpp v22, v22, v22 quad_perm:[1,0,3,2] row_mask:0xf bank_mask:0xf
  v_add_f32_dpp v23, v23, v23 quad_perm:[1,0,3,2] row_mask:0xf bank_mask:0xf
  v_cndmask_b32 v32, v32, v20, s[96:97]
  v_cndmask_b32 v33, v33, v21, s[96:97]
  v_cndmask_b32 v34, v34, v22, s[96:97]
  v_cndmask_b32 v35, v35, v23, s[96:97]
  v_mfma_f32_16x16x32_bf16 v[12:15], v[96:99], v[4:7], 0
  s_waitcnt vmcnt(4)
  buffer_load_dwordx4 v[72:75], v1, s[40:43], s7 offen offset:512 nt
  v_mfma_f32_16x16x32_bf16 v[12:15], v[100:103], v[8:11], v[12:15]
  v_mfma_f32_16x16x32_bf16 v[16:19], v[104:107], v[4:7], 0
  v_mfma_f32_16x16x32_bf16 v[16:19], v[108:111], v[8:11], v[16:19]
  s_nop 5
  v_cndmask_b32 v20, v12, v13, s[84:85]
  v_cndmask_b32 v21, v14, v15, s[84:85]
  v_cndmask_b32 v22, v16, v17, s[84:85]
  v_cndmask_b32 v23, v18, v19, s[84:85]
  v_add_f32_dpp v20, v20, v20 quad_perm:[1,0,3,2] row_mask:0xf bank_mask:0xf
  v_add_f32_dpp v21, v21, v21 quad_perm:[1,0,3,2] row_mask:0xf bank_mask:0xf
  v_add_f32_dpp v22, v22, v22 quad_perm:[1,0,3,2] row_mask:0xf bank_mask:0xf
  v_add_f32_dpp v23, v23, v23 quad_perm:[1,0,3,2] row_mask:0xf bank_mask:0xf
  v_cndmask_b32 v32, v32, v20, s[98:99]
  v_cndmask_b32 v33, v33, v21, s[98:99]
  v_cndmask_b32 v34, v34, v22, s[98:99]
  v_cndmask_b32 v35, v35, v23, s[98:99]
  s_waitcnt vmcnt(4)
  buffer_load_dwordx4 v[76:79], v1, s[40:43], s7 offen offset:640 nt
  v_mfma_f32_16x16x32_bf16 v[12:15], v[112:115], v[4:7], 0
  v_mfma_f32_16x16x32_bf16 v[12:15], v[116:119], v[8:11], v[12:15]
  v_mfma_f32_16x16x32_bf16 v[16:19], v[120:123], v[4:7], 0
  s_waitcnt vmcnt(4)
  s_add_u32 s7, s7, 32768
  buffer_load_dwordx4 v[80:83], v1, s[40:43], s7 offen offset:0 nt
  v_mfma_f32_16x16x32_bf16 v[16:19], v[124:127], v[8:11], v[16:19]
  s_nop 2
  v_cndmask_b32 v20, v12, v13, s[84:85]
  v_cndmask_b32 v21, v14, v15, s[84:85]
  s_nop 2
  v_cndmask_b32 v22, v16, v17, s[84:85]
  v_cndmask_b32 v23, v18, v19, s[84:85]
  v_add_f32_dpp v20, v20, v20 quad_perm:[1,0,3,2] row_mask:0xf bank_mask:0xf
  v_add_f32_dpp v21, v21, v21 quad_perm:[1,0,3,2] row_mask:0xf bank_mask:0xf
  v_add_f32_dpp v22, v22, v22 quad_perm:[1,0,3,2] row_mask:0xf bank_mask:0xf
  v_add_f32_dpp v23, v23, v23 quad_perm:[1,0,3,2] row_mask:0xf bank_mask:0xf
  v_cndmask_b32 v32, v32, v20, s[100:101]
  v_cndmask_b32 v33, v33, v21, s[100:101]
  v_cndmask_b32 v34, v34, v22, s[100:101]
  v_cndmask_b32 v35, v35, v23, s[100:101]
  v_max3_f32 v28, v32, v33, v34
  v_max_f32 v28, v28, v35
  v_mfma_f32_16x16x32_bf16 v[12:15], v[128:131], v[4:7], 0
  v_mfma_f32_16x16x32_bf16 v[12:15], v[132:135], v[8:11], v[12:15]
  s_waitcnt vmcnt(4)
  buffer_load_dwordx4 v[84:87], v1, s[40:43], s7 offen offset:128 nt
  v_mfma_f32_16x16x32_bf16 v[16:19], v[136:139], v[4:7], 0
  v_mfma_f32_16x16x32_bf16 v[16:19], v[140:143], v[8:11], v[16:19]
  s_nop 3
  v_cndmask_b32 v20, v12, v13, s[84:85]
  v_cndmask_b32 v21, v14, v15, s[84:85]
  s_nop 1
  v_cndmask_b32 v22, v16, v17, s[84:85]
  v_cndmask_b32 v23, v18, v19, s[84:85]
  v_add_f32_dpp v36, v20, v20 quad_perm:[1,0,3,2] row_mask:0xf bank_mask:0xf
  v_add_f32_dpp v37, v21, v21 quad_perm:[1,0,3,2] row_mask:0xf bank_mask:0xf
  v_add_f32_dpp v38, v22, v22 quad_perm:[1,0,3,2] row_mask:0xf bank_mask:0xf
  v_add_f32_dpp v39, v23, v23 quad_perm:[1,0,3,2] row_mask:0xf bank_mask:0xf
  v_mfma_f32_16x16x32_bf16 v[12:15], v[144:147], v[4:7], 0
  s_waitcnt vmcnt(4)
  buffer_load_dwordx4 v[88:91], v1, s[40:43], s7 offen offset:512 nt
  v_mfma_f32_16x16x32_bf16 v[12:15], v[148:151], v[8:11], v[12:15]
  v_mfma_f32_16x16x32_bf16 v[16:19], v[152:155], v[4:7], 0
  v_mfma_f32_16x16x32_bf16 v[16:19], v[156:159], v[8:11], v[16:19]
  s_nop 5
  v_cndmask_b32 v20, v12, v13, s[84:85]
  v_cndmask_b32 v21, v14, v15, s[84:85]
  v_cndmask_b32 v22, v16, v17, s[84:85]
  v_cndmask_b32 v23, v18, v19, s[84:85]
  v_add_f32_dpp v20, v20, v20 quad_perm:[1,0,3,2] row_mask:0xf bank_mask:0xf
  v_add_f32_dpp v21, v21, v21 quad_perm:[1,0,3,2] row_mask:0xf bank_mask:0xf
  v_add_f32_dpp v22, v22, v22 quad_perm:[1,0,3,2] row_mask:0xf bank_mask:0xf
  v_add_f32_dpp v23, v23, v23 quad_perm:[1,0,3,2] row_mask:0xf bank_mask:0xf
  v_cndmask_b32 v36, v36, v20, s[96:97]
  v_cndmask_b32 v37, v37, v21, s[96:97]
  v_cndmask_b32 v38, v38, v22, s[96:97]
  v_cndmask_b32 v39, v39, v23, s[96:97]
  s_waitcnt vmcnt(4)
  buffer_load_dwordx4 v[92:95], v1, s[40:43], s7 offen offset:640 nt
  v_mfma_f32_16x16x32_bf16 v[12:15], v[160:163], v[4:7], 0
  v_mfma_f32_16x16x32_bf16 v[12:15], v[164:167], v[8:11], v[12:15]
  v_mfma_f32_16x16x32_bf16 v[16:19], v[168:171], v[4:7], 0
  s_waitcnt vmcnt(4)
  s_add_u32 s7, s7, 32768
  buffer_load_dwordx4 v[96:99], v1, s[40:43], s7 offen offset:0 nt
  v_mfma_f32_16x16x32_bf16 v[16:19], v[172:175], v[8:11], v[16:19]
  s_nop 2
  v_cndmask_b32 v20, v12, v13, s[84:85]
  v_cndmask_b32 v21, v14, v15, s[84:85]
  s_nop 2
  v_cndmask_b32 v22, v16, v17, s[84:85]
  v_cndmask_b32 v23, v18, v19, s[84:85]
  v_add_f32_dpp v20, v20, v20 quad_perm:[1,0,3,2] row_mask:0xf bank_mask:0xf
  v_add_f32_dpp v21, v21, v21 quad_perm:[1,0,3,2] row_mask:0xf bank_mask:0xf
  v_add_f32_dpp v22, v22, v22 quad_perm:[1,0,3,2] row_mask:0xf bank_mask:0xf
  v_add_f32_dpp v23, v23, v23 quad_perm:[1,0,3,2] row_mask:0xf bank_mask:0xf
  v_cndmask_b32 v36, v36, v20, s[98:99]
  v_cndmask_b32 v37, v37, v21, s[98:99]
  v_cndmask_b32 v38, v38, v22, s[98:99]
  v_cndmask_b32 v39, v39, v23, s[98:99]
  v_mfma_f32_16x16x32_bf16 v[12:15], v[176:179], v[4:7], 0
  v_mfma_f32_16x16x32_bf16 v[12:15], v[180:183], v[8:11], v[12:15]
  s_waitcnt vmcnt(4)
  buffer_load_dwordx4 v[100:103], v1, s[40:43], s7 offen offset:128 nt
  v_mfma_f32_16x16x32_bf16 v[16:19], v[184:187], v[4:7], 0
  v_mfma_f32_16x16x32_bf16 v[16:19], v[188:191], v[8:11], v[16:19]
  s_nop 3
  v_cndmask_b32 v20, v12, v13, s[84:85]
  v_cndmask_b32 v21, v14, v15, s[84:85]
  s_nop 1
  v_cndmask_b32 v22, v16, v17, s[84:85]
  v_cndmask_b32 v23, v18, v19, s[84:85]
  v_add_f32_dpp v20, v20, v20 quad_perm:[1,0,3,2] row_mask:0xf bank_mask:0xf
  v_add_f32_dpp v21, v21, v21 quad_perm:[1,0,3,2] row_mask:0xf bank_mask:0xf
  v_add_f32_dpp v22, v22, v22 quad_perm:[1,0,3,2] row_mask:0xf bank_mask:0xf
  v_add_f32_dpp v23, v23, v23 quad_perm:[1,0,3,2] row_mask:0xf bank_mask:0xf
  v_cndmask_b32 v36, v36, v20, s[100:101]
  v_cndmask_b32 v37, v37, v21, s[100:101]
  v_cndmask_b32 v38, v38, v22, s[100:101]
  v_cndmask_b32 v39, v39, v23, s[100:101]
  v_max3_f32 v28, v28, v36, v37
  v_max3_f32 v28, v28, v38, v39
  v_mfma_f32_16x16x32_bf16 v[12:15], v[192:195], v[4:7], 0
  s_waitcnt vmcnt(4)
  buffer_load_dwordx4 v[104:107], v1, s[40:43], s7 offen offset:512 nt
  v_mfma_f32_16x16x32_bf16 v[12:15], v[196:199], v[8:11], v[12:15]
  v_mfma_f32_16x16x32_bf16 v[16:19], v[200:203], v[4:7], 0
  v_mfma_f32_16x16x32_bf16 v[16:19], v[204:207], v[8:11], v[16:19]
  s_nop 5
  v_cndmask_b32 v20, v12, v13, s[84:85]
  v_cndmask_b32 v21, v14, v15, s[84:85]
  v_cndmask_b32 v22, v16, v17, s[84:85]
  v_cndmask_b32 v23, v18, v19, s[84:85]
  v_add_f32_dpp v40, v20, v20 quad_perm:[1,0,3,2] row_mask:0xf bank_mask:0xf
  v_add_f32_dpp v41, v21, v21 quad_perm:[1,0,3,2] row_mask:0xf bank_mask:0xf
  v_add_f32_dpp v42, v22, v22 quad_perm:[1,0,3,2] row_mask:0xf bank_mask:0xf
  v_add_f32_dpp v43, v23, v23 quad_perm:[1,0,3,2] row_mask:0xf bank_mask:0xf
  s_waitcnt vmcnt(4)
  buffer_load_dwordx4 v[108:111], v1, s[40:43], s7 offen offset:640 nt
  v_mfma_f32_16x16x32_bf16 v[12:15], v[208:211], v[4:7], 0
  v_mfma_f32_16x16x32_bf16 v[12:15], v[212:215], v[8:11], v[12:15]
  v_mfma_f32_16x16x32_bf16 v[16:19], v[216:219], v[4:7], 0
  s_waitcnt vmcnt(4)
  s_add_u32 s7, s7, 32768
  buffer_load_dwordx4 v[112:115], v1, s[40:43], s7 offen offset:0 nt
  v_mfma_f32_16x16x32_bf16 v[16:19], v[220:223], v[8:11], v[16:19]
  s_nop 2
  v_cndmask_b32 v20, v12, v13, s[84:85]
  v_cndmask_b32 v21, v14, v15, s[84:85]
  s_nop 2
  v_cndmask_b32 v22, v16, v17, s[84:85]
  v_cndmask_b32 v23, v18, v19, s[84:85]
  v_add_f32_dpp v20, v20, v20 quad_perm:[1,0,3,2] row_mask:0xf bank_mask:0xf
  v_add_f32_dpp v21, v21, v21 quad_perm:[1,0,3,2] row_mask:0xf bank_mask:0xf
  v_add_f32_dpp v22, v22, v22 quad_perm:[1,0,3,2] row_mask:0xf bank_mask:0xf
  v_add_f32_dpp v23, v23, v23 quad_perm:[1,0,3,2] row_mask:0xf bank_mask:0xf
  v_cndmask_b32 v40, v40, v20, s[96:97]
  v_cndmask_b32 v41, v41, v21, s[96:97]
  v_cndmask_b32 v42, v42, v22, s[96:97]
  v_cndmask_b32 v43, v43, v23, s[96:97]
  v_mfma_f32_16x16x32_bf16 v[12:15], v[224:227], v[4:7], 0
  v_mfma_f32_16x16x32_bf16 v[12:15], v[228:231], v[8:11], v[12:15]
  s_waitcnt vmcnt(4)
  buffer_load_dwordx4 v[116:119], v1, s[40:43], s7 offen offset:128 nt
  v_mfma_f32_16x16x32_bf16 v[16:19], v[232:235], v[4:7], 0
  v_mfma_f32_16x16x32_bf16 v[16:19], v[236:239], v[8:11], v[16:19]
  s_nop 3
  v_cndmask_b32 v20, v12, v13, s[84:85]
  v_cndmask_b32 v21, v14, v15, s[84:85]
  s_nop 1
  v_cndmask_b32 v22, v16, v17, s[84:85]
  v_cndmask_b32 v23, v18, v19, s[84:85]
  v_add_f32_dpp v20, v20, v20 quad_perm:[1,0,3,2] row_mask:0xf bank_mask:0xf
  v_add_f32_dpp v21, v21, v21 quad_perm:[1,0,3,2] row_mask:0xf bank_mask:0xf
  v_add_f32_dpp v22, v22, v22 quad_perm:[1,0,3,2] row_mask:0xf bank_mask:0xf
  v_add_f32_dpp v23, v23, v23 quad_perm:[1,0,3,2] row_mask:0xf bank_mask:0xf
  v_cndmask_b32 v40, v40, v20, s[98:99]
  v_cndmask_b32 v41, v41, v21, s[98:99]
  v_cndmask_b32 v42, v42, v22, s[98:99]
  v_cndmask_b32 v43, v43, v23, s[98:99]
  v_mfma_f32_16x16x32_bf16 v[12:15], v[240:243], v[4:7], 0
  s_waitcnt vmcnt(4)
  buffer_load_dwordx4 v[120:123], v1, s[40:43], s7 offen offset:512 nt
  v_mfma_f32_16x16x32_bf16 v[12:15], v[244:247], v[8:11], v[12:15]
  v_mfma_f32_16x16x32_bf16 v[16:19], v[248:251], v[4:7], 0
  v_mfma_f32_16x16x32_bf16 v[16:19], v[252:255], v[8:11], v[16:19]
  s_nop 5
  v_cndmask_b32 v20, v12, v13, s[84:85]
  v_cndmask_b32 v21, v14, v15, s[84:85]
  v_cndmask_b32 v22, v16, v17, s[84:85]
  v_cndmask_b32 v23, v18, v19, s[84:85]
  v_add_f32_dpp v20, v20, v20 quad_perm:[1,0,3,2] row_mask:0xf bank_mask:0xf
  v_add_f32_dpp v21, v21, v21 quad_perm:[1,0,3,2] row_mask:0xf bank_mask:0xf
  v_add_f32_dpp v22, v22, v22 quad_perm:[1,0,3,2] row_mask:0xf bank_mask:0xf
  v_add_f32_dpp v23, v23, v23 quad_perm:[1,0,3,2] row_mask:0xf bank_mask:0xf
  v_cndmask_b32 v40, v40, v20, s[100:101]
  v_cndmask_b32 v41, v41, v21, s[100:101]
  v_cndmask_b32 v42, v42, v22, s[100:101]
  v_cndmask_b32 v43, v43, v23, s[100:101]
  v_max3_f32 v28, v28, v40, v41
  v_max3_f32 v28, v28, v42, v43
  s_waitcnt vmcnt(4)
  buffer_load_dwordx4 v[124:127], v1, s[40:43], s7 offen offset:640 nt
  v_mfma_f32_16x16x32_bf16 v[12:15], v[64:67], v[4:7], 0
  v_mfma_f32_16x16x32_bf16 v[12:15], v[68:71], v[8:11], v[12:15]
  v_mfma_f32_16x16x32_bf16 v[16:19], v[72:75], v[4:7], 0
  s_waitcnt vmcnt(4)
  s_add_u32 s7, s7, 32768
  buffer_load_dwordx4 v[128:131], v1, s[40:43], s7 offen offset:0 nt
  ds_add_u32 v3, v30 offset:10000
  v_mfma_f32_16x16x32_bf16 v[16:19], v[76:79], v[8:11], v[16:19]
  s_nop 1
  v_cndmask_b32 v20, v12, v13, s[84:85]
  v_cndmask_b32 v21, v14, v15, s[84:85]
  s_nop 3
  v_cndmask_b32 v22, v16, v17, s[84:85]
  v_cndmask_b32 v23, v18, v19, s[84:85]
  v_add_f32_dpp v44, v20, v20 quad_perm:[1,0,3,2] row_mask:0xf bank_mask:0xf
  v_add_f32_dpp v45, v21, v21 quad_perm:[1,0,3,2] row_mask:0xf bank_mask:0xf
  v_add_f32_dpp v46, v22, v22 quad_perm:[1,0,3,2] row_mask:0xf bank_mask:0xf
  v_add_f32_dpp v47, v23, v23 quad_perm:[1,0,3,2] row_mask:0xf bank_mask:0xf
  v_mfma_f32_16x16x32_bf16 v[12:15], v[80:83], v[4:7], 0
  v_mfma_f32_16x16x32_bf16 v[12:15], v[84:87], v[8:11], v[12:15]
  s_cbranch_vccnz L_sk65
  s_waitcnt vmcnt(4)
L_sk65:
  s_waitcnt vmcnt(5)
  buffer_load_dwordx4 v[132:135], v1, s[40:43], s7 offen offset:128 nt
  ds_read_b32 v31, v3 offset:9996
  v_mfma_f32_16x16x32_bf16 v[16:19], v[88:91], v[4:7], 0
  v_mfma_f32_16x16x32_bf16 v[16:19], v[92:95], v[8:11], v[16:19]
  s_nop 1
  v_cndmask_b32 v20, v12, v13, s[84:85]
  v_cndmask_b32 v21, v14, v15, s[84:85]
  s_nop 3
  v_cndmask_b32 v22, v16, v17, s[84:85]
  v_cndmask_b32 v23, v18, v19, s[84:85]
  v_add_f32_dpp v20, v20, v20 quad_perm:[1,0,3,2] row_mask:0xf bank_mask:0xf
  v_add_f32_dpp v21, v21, v21 quad_perm:[1,0,3,2] row_mask:0xf bank_mask:0xf
  v_add_f32_dpp v22, v22, v22 quad_perm:[1,0,3,2] row_mask:0xf bank_mask:0xf
  v_add_f32_dpp v23, v23, v23 quad_perm:[1,0,3,2] row_mask:0xf bank_mask:0xf
  v_cndmask_b32 v44, v44, v20, s[96:97]
  v_cndmask_b32 v45, v45, v21, s[96:97]
  v_cndmask_b32 v46, v46, v22, s[96:97]
  v_cndmask_b32 v47, v47, v23, s[96:97]
  v_mfma_f32_16x16x32_bf16 v[12:15], v[96:99], v[4:7], 0
  s_cbranch_vccnz L_sk66
  s_waitcnt vmcnt(4)
L_sk66:
  s_waitcnt vmcnt(5) lgkmcnt(0)
  buffer_load_dwordx4 v[136:139], v1, s[40:43], s7 offen offset:512 nt
  v_cmp_ne_u32 vcc, 0, v31
  v_mfma_f32_16x16x32_bf16 v[12:15], v[100:103], v[8:11], v[12:15]
  v_mfma_f32_16x16x32_bf16 v[16:19], v[104:107], v[4:7], 0
  v_mfma_f32_16x16x32_bf16 v[16:19], v[108:111], v[8:11], v[16:19]
  s_nop 5
  v_cndmask_b32 v20, v12, v13, s[84:85]
  v_cndmask_b32 v21, v14, v15, s[84:85]
  v_cndmask_b32 v22, v16, v17, s[84:85]
  v_cndmask_b32 v23, v18, v19, s[84:85]
  v_add_f32_dpp v20, v20, v20 quad_perm:[1,0,3,2] row_mask:0xf bank_mask:0xf
  v_add_f32_dpp v21, v21, v21 quad_perm:[1,0,3,2] row_mask:0xf bank_mask:0xf
  v_add_f32_dpp v22, v22, v22 quad_perm:[1,0,3,2] row_mask:0xf bank_mask:0xf
  v_add_f32_dpp v23, v23, v23 quad_perm:[1,0,3,2] row_mask:0xf bank_mask:0xf
  v_cndmask_b32 v44, v44, v20, s[98:99]
  v_cndmask_b32 v45, v45, v21, s[98:99]
  v_cndmask_b32 v46, v46, v22, s[98:99]
  v_cndmask_b32 v47, v47, v23, s[98:99]
  s_waitcnt vmcnt(4)
  buffer_load_dwordx4 v[140:143], v1, s[40:43], s7 offen offset:640 nt
  v_mfma_f32_16x16x32_bf16 v[12:15], v[112:115], v[4:7], 0
  v_mfma_f32_16x16x32_bf16 v[12:15], v[116:119], v[8:11], v[12:15]
  v_mfma_f32_16x16x32_bf16 v[16:19], v[120:123], v[4:7], 0
  s_cbranch_vccnz L_sk68
  s_waitcnt vmcnt(4)
L_sk68:
  s_waitcnt vmcnt(5)
  s_add_u32 s7, s7, 32768
  buffer_load_dwordx4 v[144:147], v1, s[40:43], s7 offen offset:0 nt
  s_cbranch_vccnz L_sk69
  s_waitcnt vmcnt(4)
L_sk69:
  s_waitcnt vmcnt(5)
  buffer_load_dwordx4 v[148:151], v1, s[40:43], s7 offen offset:128 nt
  ds_read_b32 v31, v3 offset:9996
  v_mfma_f32_16x16x32_bf16 v[16:19], v[124:127], v[8:11], v[16:19]
  v_cndmask_b32 v20, v12, v13, s[84:85]
  v_cndmask_b32 v21, v14, v15, s[84:85]
  s_nop 5
  v_cndmask_b32 v22, v16, v17, s[84:85]
  v_cndmask_b32 v23, v18, v19, s[84:85]
  v_add_f32_dpp v20, v20, v20 quad_perm:[1,0,3,2] row_mask:0xf bank_mask:0xf
  v_add_f32_dpp v21, v21, v21 quad_perm:[1,0,3,2] row_mask:0xf bank_mask:0xf
  v_add_f32_dpp v22, v22, v22 quad_perm:[1,0,3,2] row_mask:0xf bank_mask:0xf
  v_add_f32_dpp v23, v23, v23 quad_perm:[1,0,3,2] row_mask:0xf bank_mask:0xf
  v_cndmask_b32 v44, v44, v20, s[100:101]
  v_cndmask_b32 v45, v45, v21, s[100:101]
  v_cndmask_b32 v46, v46, v22, s[100:101]
  v_cndmask_b32 v47, v47, v23, s[100:101]
  v_max3_f32 v28, v28, v44, v45
  v_max3_f32 v28, v28, v46, v47
  s_cbranch_vccnz L_sk70
  s_waitcnt vmcnt(4)
L_sk70:
  s_waitcnt vmcnt(5) lgkmcnt(0)
  buffer_load_dwordx4 v[152:155], v1, s[40:43], s7 offen offset:512 nt
  v_cmp_ne_u32 vcc, 0, v31
  v_mfma_f32_16x16x32_bf16 v[12:15], v[128:131], v[4:7], 0
  s_waitcnt vmcnt(4)
  buffer_load_dwordx4 v[156:159], v1, s[40:43], s7 offen offset:640 nt
  v_mfma_f32_16x16x32_bf16 v[12:15], v[132:135], v[8:11], v[12:15]
  v_mfma_f32_16x16x32_bf16 v[16:19], v[136:139], v[4:7], 0
  s_cbranch_vccnz L_sk72
  s_waitcnt vmcnt(4)
L_sk72:
  s_waitcnt vmcnt(5)
  s_add_u32 s7, s7, 32768
  buffer_load_dwordx4 v[160:163], v1, s[40:43], s7 offen offset:0 nt
  s_cbranch_vccnz L_sk73
  s_waitcnt vmcnt(4)
L_sk73:
  s_waitcnt vmcnt(5)
  buffer_load_dwordx4 v[164:167], v1, s[40:43], s7 offen offset:128 nt
  ds_read_b32 v31, v3 offset:9996
  v_mfma_f32_16x16x32_bf16 v[16:19], v[140:143], v[8:11], v[16:19]
  v_cndmask_b32 v20, v12, v13, s[84:85]
  v_cndmask_b32 v21, v14, v15, s[84:85]
  s_nop 5
  v_cndmask_b32 v22, v16, v17, s[84:85]
  v_cndmask_b32 v23, v18, v19, s[84:85]
  v_add_f32_dpp v48, v20, v20 quad_perm:[1,0,3,2] row_mask:0xf bank_mask:0xf
  v_add_f32_dpp v49, v21, v21 quad_perm:[1,0,3,2] row_mask:0xf bank_mask:0xf
  v_add_f32_dpp v50, v22, v22 quad_perm:[1,0,3,2] row_mask:0xf bank_mask:0xf
  v_add_f32_dpp v51, v23, v23 quad_perm:[1,0,3,2] row_mask:0xf bank_mask:0xf
  s_cbranch_vccnz L_sk74
  s_waitcnt vmcnt(4)
L_sk74:
  s_waitcnt vmcnt(5) lgkmcnt(0)
  buffer_load_dwordx4 v[168:171], v1, s[40:43], s7 offen offset:512 nt
  v_cmp_ne_u32 vcc, 0, v31
  v_mfma_f32_16x16x32_bf16 v[12:15], v[144:147], v[4:7], 0
  s_waitcnt vmcnt(4)
  buffer_load_dwordx4 v[172:175], v1, s[40:43], s7 offen offset:640 nt
  v_mfma_f32_16x16x32_bf16 v[12:15], v[148:151], v[8:11], v[12:15]
  v_mfma_f32_16x16x32_bf16 v[16:19], v[152:155], v[4:7], 0
  s_cbranch_vccnz L_sk76
  s_waitcnt vmcnt(4)
L_sk76:
  s_waitcnt vmcnt(5)
  s_add_u32 s7, s7, 32768
  buffer_load_dwordx4 v[176:179], v1, s[40:43], s7 offen offset:0 nt
  s_cbranch_vccnz L_sk77
  s_waitcnt vmcnt(4)
L_sk77:
  s_waitcnt vmcnt(5)
  buffer_load_dwordx4 v[180:183], v1, s[40:43], s7 offen offset:128 nt
  ds_read_b32 v31, v3 offset:9996
  v_mfma_f32_16x16x32_bf16 v[16:19], v[156:159], v[8:11], v[16:19]
  v_cndmask_b32 v20, v12, v13, s[84:85]
  v_cndmask_b32 v21, v14, v15, s[84:85]
  s_nop 5
  v_cndmask_b32 v22, v16, v17, s[84:85]
  v_cndmask_b32 v23, v18, v19, s[84:85]
  v_add_f32_dpp v20, v20, v20 quad_perm:[1,0,3,2] row_mask:0xf bank_mask:0xf
  v_add_f32_dpp v21, v21, v21 quad_perm:[1,0,3,2] row_mask:0xf bank_mask:0xf
  v_add_f32_dpp v22, v22, v22 quad_perm:[1,0,3,2] row_mask:0xf bank_mask:0xf
  v_add_f32_dpp v23, v23, v23 quad_perm:[1,0,3,2] row_mask:0xf bank_mask:0xf
  v_cndmask_b32 v48, v48, v20, s[96:97]
  v_cndmask_b32 v49, v49, v21, s[96:97]
  v_cndmask_b32 v50, v50, v22, s[96:97]
  v_cndmask_b32 v51, v51, v23, s[96:97]
  s_cbranch_vccnz L_sk78
  s_waitcnt vmcnt(4)
L_sk78:
  s_waitcnt vmcnt(5) lgkmcnt(0)
  buffer_load_dwordx4 v[184:187], v1, s[40:43], s7 offen offset:512 nt
  v_cmp_ne_u32 vcc, 0, v31
  v_mfma_f32_16x16x32_bf16 v[12:15], v[160:163], v[4:7], 0
  s_waitcnt vmcnt(4)
  buffer_load_dwordx4 v[188:191], v1, s[40:43], s7 offen offset:640 nt
  v_mfma_f32_16x16x32_bf16 v[12:15], v[164:167], v[8:11], v[12:15]
  v_mfma_f32_16x16x32_bf16 v[16:19], v[168:171], v[4:7], 0
  s_cbranch_vccnz L_sk80
  s_waitcnt vmcnt(4)
L_sk80:
  s_waitcnt vmcnt(5)
  s_add_u32 s7, s7, 32768
  buffer_load_dwordx4 v[192:195], v1, s[40:43], s7 offen offset:0 nt
  s_cbranch_vccnz L_sk81
  s_waitcnt vmcnt(4)
L_sk81:
  s_waitcnt vmcnt(5)
  buffer_load_dwordx4 v[196:199], v1, s[40:43], s7 offen offset:128 nt
  ds_read_b32 v31, v3 offset:9996
  v_mfma_f32_16x16x32_bf16 v[16:19], v[172:175], v[8:11], v[16:19]
  v_cndmask_b32 v20, v12, v13, s[84:85]
  v_cndmask_b32 v21, v14, v15, s[84:85]
  s_nop 5
  v_cndmask_b32 v22, v16, v17, s[84:85]
  v_cndmask_b32 v23, v18, v19, s[84:85]
  v_add_f32_dpp v20, v20, v20 quad_perm:[1,0,3,2] row_mask:0xf bank_mask:0xf
  v_add_f32_dpp v21, v21, v21 quad_perm:[1,0,3,2] row_mask:0xf bank_mask:0xf
  v_add_f32_dpp v22, v22, v22 quad_perm:[1,0,3,2] row_mask:0xf bank_mask:0xf
  v_add_f32_dpp v23, v23, v23 quad_perm:[1,0,3,2] row_mask:0xf bank_mask:0xf
  v_cndmask_b32 v48, v48, v20, s[98:99]
  v_cndmask_b32 v49, v49, v21, s[98:99]
  v_cndmask_b32 v50, v50, v22, s[98:99]
  v_cndmask_b32 v51, v51, v23, s[98:99]
  s_cbranch_vccnz L_sk82
  s_waitcnt vmcnt(4)
L_sk82:
  s_waitcnt vmcnt(5) lgkmcnt(0)
  buffer_load_dwordx4 v[200:203], v1, s[40:43], s7 offen offset:512 nt
  v_cmp_ne_u32 vcc, 0, v31
  v_mfma_f32_16x16x32_bf16 v[12:15], v[176:179], v[4:7], 0
  s_waitcnt vmcnt(4)
  buffer_load_dwordx4 v[204:207], v1, s[40:43], s7 offen offset:640 nt
  v_mfma_f32_16x16x32_bf16 v[12:15], v[180:183], v[8:11], v[12:15]
  v_mfma_f32_16x16x32_bf16 v[16:19], v[184:187], v[4:7], 0
  s_cbranch_vccnz L_sk84
  s_waitcnt vmcnt(4)
L_sk84:
  s_waitcnt vmcnt(5)
  s_add_u32 s7, s7, 32768
  buffer_load_dwordx4 v[208:211], v1, s[40:43], s7 offen offset:0 nt
  s_cbranch_vccnz L_sk85
  s_waitcnt vmcnt(4)
L_sk85:
  s_waitcnt vmcnt(5)
  buffer_load_dwordx4 v[212:215], v1, s[40:43], s7 offen offset:128 nt
  ds_read_b32 v31, v3 offset:9996
  v_mfma_f32_16x16x32_bf16 v[16:19], v[188:191], v[8:11], v[16:19]
  v_cndmask_b32 v20, v12, v13, s[84:85]
  v_cndmask_b32 v21, v14, v15, s[84:85]
  s_nop 5
  v_cndmask_b32 v22, v16, v17, s[84:85]
  v_cndmask_b32 v23, v18, v19, s[84:85]
  v_add_f32_dpp v20, v20, v20 quad_perm:[1,0,3,2] row_mask:0xf bank_mask:0xf
  v_add_f32_dpp v21, v21, v21 quad_perm:[1,0,3,2] row_mask:0xf bank_mask:0xf
  v_add_f32_dpp v22, v22, v22 quad_perm:[1,0,3,2] row_mask:0xf bank_mask:0xf
  v_add_f32_dpp v23, v23, v23 quad_perm:[1,0,3,2] row_mask:0xf bank_mask:0xf
  v_cndmask_b32 v48, v48, v20, s[100:101]
  v_cndmask_b32 v49, v49, v21, s[100:101]
  v_cndmask_b32 v50, v50, v22, s[100:101]
  v_cndmask_b32 v51, v51, v23, s[100:101]
  v_max3_f32 v28, v28, v48, v49
  v_max3_f32 v28, v28, v50, v51
  s_cbranch_vccnz L_sk86
  s_waitcnt vmcnt(4)
L_sk86:
  s_waitcnt vmcnt(5) lgkmcnt(0)
  buffer_load_dwordx4 v[216:219], v1, s[40:43], s7 offen offset:512 nt
  v_cmp_ne_u32 vcc, 0, v31
  v_mfma_f32_16x16x32_bf16 v[12:15], v[192:195], v[4:7], 0
  s_waitcnt vmcnt(4)
  buffer_load_dwordx4 v[220:223], v1, s[40:43], s7 offen offset:640 nt
  v_mfma_f32_16x16x32_bf16 v[12:15], v[196:199], v[8:11], v[12:15]
  v_mfma_f32_16x16x32_bf16 v[16:19], v[200:203], v[4:7], 0
  s_cbranch_vccnz L_sk88
  s_waitcnt vmcnt(4)
L_sk88:
  s_waitcnt vmcnt(5)
  s_add_u32 s7, s7, 32768
  buffer_load_dwordx4 v[224:227], v1, s[40:43], s7 offen offset:0 nt
  s_cbranch_vccnz L_sk89
  s_waitcnt vmcnt(4)
L_sk89:
  s_waitcnt vmcnt(5)
  buffer_load_dwordx4 v[228:231], v1, s[40:43], s7 offen offset:128 nt
  ds_read_b32 v31, v3 offset:9996
  v_mfma_f32_16x16x32_bf16 v[16:19], v[204:207], v[8:11], v[16:19]
  v_cndmask_b32 v20, v12, v13, s[84:85]
  v_cndmask_b32 v21, v14, v15, s[84:85]
  s_nop 5
  v_cndmask_b32 v22, v16, v17, s[84:85]
  v_cndmask_b32 v23, v18, v19, s[84:85]
  v_add_f32_dpp v52, v20, v20 quad_perm:[1,0,3,2] row_mask:0xf bank_mask:0xf
  v_add_f32_dpp v53, v21, v21 quad_perm:[1,0,3,2] row_mask:0xf bank_mask:0xf
  v_add_f32_dpp v54, v22, v22 quad_perm:[1,0,3,2] row_mask:0xf bank_mask:0xf
  v_add_f32_dpp v55, v23, v23 quad_perm:[1,0,3,2] row_mask:0xf bank_mask:0xf
  s_cbranch_vccnz L_sk90
  s_waitcnt vmcnt(4)
L_sk90:
  s_waitcnt vmcnt(5) lgkmcnt(0)
  buffer_load_dwordx4 v[232:235], v1, s[40:43], s7 offen offset:512 nt
  v_cmp_ne_u32 vcc, 0, v31
  v_mfma_f32_16x16x32_bf16 v[12:15], v[208:211], v[4:7], 0
  s_waitcnt vmcnt(4)
  buffer_load_dwordx4 v[236:239], v1, s[40:43], s7 offen offset:640 nt
  v_mfma_f32_16x16x32_bf16 v[12:15], v[212:215], v[8:11], v[12:15]
  v_mfma_f32_16x16x32_bf16 v[16:19], v[216:219], v[4:7], 0
  s_cbranch_vccnz L_sk92
  s_waitcnt vmcnt(4)
L_sk92:
  s_waitcnt vmcnt(5)
  s_add_u32 s7, s7, 32768
  buffer_load_dwordx4 v[240:243], v1, s[40:43], s7 offen offset:0 nt
  s_cbranch_vccnz L_sk93
  s_waitcnt vmcnt(4)
L_sk93:
  s_waitcnt vmcnt(5)
  buffer_load_dwordx4 v[244:247], v1, s[40:43], s7 offen offset:128 nt
  ds_read_b32 v31, v3 offset:9996
  v_mfma_f32_16x16x32_bf16 v[16:19], v[220:223], v[8:11], v[16:19]
  v_cndmask_b32 v20, v12, v13, s[84:85]
  v_cndmask_b32 v21, v14, v15, s[84:85]
  s_nop 5
  v_cndmask_b32 v22, v16, v17, s[84:85]
  v_cndmask_b32 v23, v18, v19, s[84:85]
  v_add_f32_dpp v20, v20, v20 quad_perm:[1,0,3,2] row_mask:0xf bank_mask:0xf
  v_add_f32_dpp v21, v21, v21 quad_perm:[1,0,3,2] row_mask:0xf bank_mask:0xf
  v_add_f32_dpp v22, v22, v22 quad_perm:[1,0,3,2] row_mask:0xf bank_mask:0xf
  v_add_f32_dpp v23, v23, v23 quad_perm:[1,0,3,2] row_mask:0xf bank_mask:0xf
  v_cndmask_b32 v52, v52, v20, s[96:97]
  v_cndmask_b32 v53, v53, v21, s[96:97]
  v_cndmask_b32 v54, v54, v22, s[96:97]
  v_cndmask_b32 v55, v55, v23, s[96:97]
  s_cbranch_vccnz L_sk94
  s_waitcnt vmcnt(4)
L_sk94:
  s_waitcnt vmcnt(5) lgkmcnt(0)
  buffer_load_dwordx4 v[248:251], v1, s[40:43], s7 offen offset:512 nt
  v_cmp_ne_u32 vcc, 0, v31
  v_mfma_f32_16x16x32_bf16 v[12:15], v[224:227], v[4:7], 0
  s_waitcnt vmcnt(4)
  buffer_load_dwordx4 v[252:255], v1, s[40:43], s7 offen offset:640 nt
  v_mfma_f32_16x16x32_bf16 v[12:15], v[228:231], v[8:11], v[12:15]
  v_mfma_f32_16x16x32_bf16 v[16:19], v[232:235], v[4:7], 0
  s_cbranch_vccnz L_sk96
  s_waitcnt vmcnt(4)
L_sk96:
  s_waitcnt vmcnt(5)
  s_add_u32 s7, s7, 32768
  buffer_load_dwordx4 v[64:67], v1, s[40:43], s7 offen offset:0 nt
  s_cbranch_vccnz L_sk97
  s_waitcnt vmcnt(4)
L_sk97:
  s_waitcnt vmcnt(5)
  buffer_load_dwordx4 v[68:71], v1, s[40:43], s7 offen offset:128 nt
  ds_read_b32 v31, v3 offset:9996
  v_mfma_f32_16x16x32_bf16 v[16:19], v[236:239], v[8:11], v[16:19]
  v_cndmask_b32 v20, v12, v13, s[84:85]
  v_cndmask_b32 v21, v14, v15, s[84:85]
  s_nop 5
  v_cndmask_b32 v22, v16, v17, s[84:85]
  v_cndmask_b32 v23, v18, v19, s[84:85]
  v_add_f32_dpp v20, v20, v20 quad_perm:[1,0,3,2] row_mask:0xf bank_mask:0xf
  v_add_f32_dpp v21, v21, v21 quad_perm:[1,0,3,2] row_mask:0xf bank_mask:0xf
  v_add_f32_dpp v22, v22, v22 quad_perm:[1,0,3,2] row_mask:0xf bank_mask:0xf
  v_add_f32_dpp v23, v23, v23 quad_perm:[1,0,3,2] row_mask:0xf bank_mask:0xf
  v_cndmask_b32 v52, v52, v20, s[98:99]
  v_cndmask_b32 v53, v53, v21, s[98:99]
  v_cndmask_b32 v54, v54, v22, s[98:99]
  v_cndmask_b32 v55, v55, v23, s[98:99]
  s_cbranch_vccnz L_sk98
  s_waitcnt vmcnt(4)
L_sk98:
  s_waitcnt vmcnt(5) lgkmcnt(0)
  buffer_load_dwordx4 v[72:75], v1, s[40:43], s7 offen offset:512 nt
  v_cmp_ne_u32 vcc, 0, v31
  v_mfma_f32_16x16x32_bf16 v[12:15], v[240:243], v[4:7], 0
  s_waitcnt vmcnt(4)
  buffer_load_dwordx4 v[76:79], v1, s[40:43], s7 offen offset:640 nt
  v_mfma_f32_16x16x32_bf16 v[12:15], v[244:247], v[8:11], v[12:15]
  v_mfma_f32_16x16x32_bf16 v[16:19], v[248:251], v[4:7], 0
  s_cbranch_vccnz L_sk100
  s_waitcnt vmcnt(4)
L_sk100:
  s_waitcnt vmcnt(5)
  s_add_u32 s7, s7, 32768
  buffer_load_dwordx4 v[80:83], v1, s[40:43], s7 offen offset:0 nt
  s_cbranch_vccnz L_sk101
  s_waitcnt vmcnt(4)
L_sk101:
  s_waitcnt vmcnt(5)
  buffer_load_dwordx4 v[84:87], v1, s[40:43], s7 offen offset:128 nt
  ds_read_b32 v31, v3 offset:9996
  v_mfma_f32_16x16x32_bf16 v[16:19], v[252:255], v[8:11], v[16:19]
  v_cndmask_b32 v20, v12, v13, s[84:85]
  v_cndmask_b32 v21, v14, v15, s[84:85]
  s_nop 5
  v_cndmask_b32 v22, v16, v17, s[84:85]
  v_cndmask_b32 v23, v18, v19, s[84:85]
  v_add_f32_dpp v20, v20, v20 quad_perm:[1,0,3,2] row_mask:0xf bank_mask:0xf
  v_add_f32_dpp v21, v21, v21 quad_perm:[1,0,3,2] row_mask:0xf bank_mask:0xf
  v_add_f32_dpp v22, v22, v22 quad_perm:[1,0,3,2] row_mask:0xf bank_mask:0xf
  v_add_f32_dpp v23, v23, v23 quad_perm:[1,0,3,2] row_mask:0xf bank_mask:0xf
  v_cndmask_b32 v52, v52, v20, s[100:101]
  v_cndmask_b32 v53, v53, v21, s[100:101]
  v_cndmask_b32 v54, v54, v22, s[100:101]
  v_cndmask_b32 v55, v55, v23, s[100:101]
  v_max3_f32 v28, v28, v52, v53
  v_max3_f32 v28, v28, v54, v55
  s_cbranch_vccnz L_sk102
  s_waitcnt vmcnt(4)
L_sk102:
  s_waitcnt vmcnt(5) lgkmcnt(0)
  buffer_load_dwordx4 v[88:91], v1, s[40:43], s7 offen offset:512 nt
  v_cmp_ne_u32 vcc, 0, v31
  v_mfma_f32_16x16x32_bf16 v[12:15], v[64:67], v[4:7], 0
  s_waitcnt vmcnt(4)
  buffer_load_dwordx4 v[92:95], v1, s[40:43], s7 offen offset:640 nt
  v_mfma_f32_16x16x32_bf16 v[12:15], v[68:71], v[8:11], v[12:15]
  v_mfma_f32_16x16x32_bf16 v[16:19], v[72:75], v[4:7], 0
  s_cbranch_vccnz L_sk104
  s_waitcnt vmcnt(4)
L_sk104:
  s_waitcnt vmcnt(5)
  s_add_u32 s7, s7, 32768
  buffer_load_dwordx4 v[96:99], v1, s[40:43], s7 offen offset:0 nt
  s_cbranch_vccnz L_sk105
  s_waitcnt vmcnt(4)
L_sk105:
  s_waitcnt vmcnt(5)
  buffer_load_dwordx4 v[100:103], v1, s[40:43], s7 offen offset:128 nt
  ds_read_b32 v31, v3 offset:9996
  v_mfma_f32_16x16x32_bf16 v[16:19], v[76:79], v[8:11], v[16:19]
  v_cndmask_b32 v20, v12, v13, s[84:85]
  v_cndmask_b32 v21, v14, v15, s[84:85]
  s_nop 5
  v_cndmask_b32 v22, v16, v17, s[84:85]
  v_cndmask_b32 v23, v18, v19, s[84:85]
  v_add_f32_dpp v56, v20, v20 quad_perm:[1,0,3,2] row_mask:0xf bank_mask:0xf
  v_add_f32_dpp v57, v21, v21 quad_perm:[1,0,3,2] row_mask:0xf bank_mask:0xf
  v_add_f32_dpp v58, v22, v22 quad_perm:[1,0,3,2] row_mask:0xf bank_mask:0xf
  v_add_f32_dpp v59, v23, v23 quad_perm:[1,0,3,2] row_mask:0xf bank_mask:0xf
  s_cbranch_vccnz L_sk106
  s_waitcnt vmcnt(4)
L_sk106:
  s_waitcnt vmcnt(5) lgkmcnt(0)
  buffer_load_dwordx4 v[104:107], v1, s[40:43], s7 offen offset:512 nt
  v_cmp_ne_u32 vcc, 0, v31
  v_mfma_f32_16x16x32_bf16 v[12:15], v[80:83], v[4:7], 0
  s_waitcnt vmcnt(4)
  buffer_load_dwordx4 v[108:111], v1, s[40:43], s7 offen offset:640 nt
  v_mfma_f32_16x16x32_bf16 v[12:15], v[84:87], v[8:11], v[12:15]
  v_mfma_f32_16x16x32_bf16 v[16:19], v[88:91], v[4:7], 0
  s_cbranch_vccnz L_sk108
  s_waitcnt vmcnt(4)
L_sk108:
  s_waitcnt vmcnt(5)
  s_add_u32 s7, s7, 32768
  buffer_load_dwordx4 v[112:115], v1, s[40:43], s7 offen offset:0 nt
  s_cbranch_vccnz L_sk109
  s_waitcnt vmcnt(4)
L_sk109:
  s_waitcnt vmcnt(5)
  buffer_load_dwordx4 v[116:119], v1, s[40:43], s7 offen offset:128 nt
  ds_read_b32 v31, v3 offset:9996
  v_mfma_f32_16x16x32_bf16 v[16:19], v[92:95], v[8:11], v[16:19]
  v_cndmask_b32 v20, v12, v13, s[84:85]
  v_cndmask_b32 v21, v14, v15, s[84:85]
  s_nop 5
  v_cndmask_b32 v22, v16, v17, s[84:85]
  v_cndmask_b32 v23, v18, v19, s[84:85]
  v_add_f32_dpp v20, v20, v20 quad_perm:[1,0,3,2] row_mask:0xf bank_mask:0xf
  v_add_f32_dpp v21, v21, v21 quad_perm:[1,0,3,2] row_mask:0xf bank_mask:0xf
  v_add_f32_dpp v22, v22, v22 quad_perm:[1,0,3,2] row_mask:0xf bank_mask:0xf
  v_add_f32_dpp v23, v23, v23 quad_perm:[1,0,3,2] row_mask:0xf bank_mask:0xf
  v_cndmask_b32 v56, v56, v20, s[96:97]
  v_cndmask_b32 v57, v57, v21, s[96:97]
  v_cndmask_b32 v58, v58, v22, s[96:97]
  v_cndmask_b32 v59, v59, v23, s[96:97]
  s_cbranch_vccnz L_sk110
  s_waitcnt vmcnt(4)
L_sk110:
  s_waitcnt vmcnt(5) lgkmcnt(0)
  buffer_load_dwordx4 v[120:123], v1, s[40:43], s7 offen offset:512 nt
  v_cmp_ne_u32 vcc, 0, v31
  v_mfma_f32_16x16x32_bf16 v[12:15], v[96:99], v[4:7], 0
  s_waitcnt vmcnt(4)
  buffer_load_dwordx4 v[124:127], v1, s[40:43], s7 offen offset:640 nt
  v_mfma_f32_16x16x32_bf16 v[12:15], v[100:103], v[8:11], v[12:15]
  v_mfma_f32_16x16x32_bf16 v[16:19], v[104:107], v[4:7], 0
  s_cbranch_vccnz L_sk112
  s_waitcnt vmcnt(4)
L_sk112:
  s_waitcnt vmcnt(5)
  s_add_u32 s7, s7, 32768
  buffer_load_dwordx4 v[128:131], v1, s[40:43], s7 offen offset:0 nt
  ds_add_u32 v3, v30 offset:10000
  s_cbranch_vccnz L_sk113
  s_waitcnt vmcnt(4)
L_sk113:
  s_waitcnt vmcnt(5)
  buffer_load_dwordx4 v[132:135], v1, s[40:43], s7 offen offset:128 nt
  ds_read_b32 v31, v3 offset:9996
  v_mfma_f32_16x16x32_bf16 v[16:19], v[108:111], v[8:11], v[16:19]
  v_cndmask_b32 v20, v12, v13, s[84:85]
  v_cndmask_b32 v21, v14, v15, s[84:85]
  s_nop 5
  v_cndmask_b32 v22, v16, v17, s[84:85]
  v_cndmask_b32 v23, v18, v19, s[84:85]
  v_add_f32_dpp v20, v20, v20 quad_perm:[1,0,3,2] row_mask:0xf bank_mask:0xf
  v_add_f32_dpp v21, v21, v21 quad_perm:[1,0,3,2] row_mask:0xf bank_mask:0xf
  v_add_f32_dpp v22, v22, v22 quad_perm:[1,0,3,2] row_mask:0xf bank_mask:0xf
  v_add_f32_dpp v23, v23, v23 quad_perm:[1,0,3,2] row_mask:0xf bank_mask:0xf
  v_cndmask_b32 v56, v56, v20, s[98:99]
  v_cndmask_b32 v57, v57, v21, s[98:99]
  v_cndmask_b32 v58, v58, v22, s[98:99]
  v_cndmask_b32 v59, v59, v23, s[98:99]
  s_cbranch_vccnz L_sk114
  s_waitcnt vmcnt(4)
L_sk114:
  s_waitcnt vmcnt(5) lgkmcnt(0)
  buffer_load_dwordx4 v[136:139], v1, s[40:43], s7 offen offset:512 nt
  v_cmp_ne_u32 vcc, 0, v31
  v_mfma_f32_16x16x32_bf16 v[12:15], v[112:115], v[4:7], 0
  s_waitcnt vmcnt(4)
  buffer_load_dwordx4 v[140:143], v1, s[40:43], s7 offen offset:640 nt
  v_mfma_f32_16x16x32_bf16 v[12:15], v[116:119], v[8:11], v[12:15]
  v_mfma_f32_16x16x32_bf16 v[16:19], v[120:123], v[4:7], 0
  s_cbranch_vccnz L_sk116
  s_waitcnt vmcnt(4)
L_sk116:
  s_waitcnt vmcnt(5)
  s_add_u32 s7, s7, 32768
  buffer_load_dwordx4 v[144:147], v1, s[40:43], s7 offen offset:0 nt
  s_cbranch_vccnz L_sk117
  s_waitcnt vmcnt(4)
L_sk117:
  s_waitcnt vmcnt(5)
  buffer_load_dwordx4 v[148:151], v1, s[40:43], s7 offen offset:128 nt
  ds_read_b32 v31, v3 offset:9996
  v_mfma_f32_16x16x32_bf16 v[16:19], v[124:127], v[8:11], v[16:19]
  v_cndmask_b32 v20, v12, v13, s[84:85]
  v_cndmask_b32 v21, v14, v15, s[84:85]
  s_nop 5
  v_cndmask_b32 v22, v16, v17, s[84:85]
  v_cndmask_b32 v23, v18, v19, s[84:85]
  v_add_f32_dpp v20, v20, v20 quad_perm:[1,0,3,2] row_mask:0xf bank_mask:0xf
  v_add_f32_dpp v21, v21, v21 quad_perm:[1,0,3,2] row_mask:0xf bank_mask:0xf
  v_add_f32_dpp v22, v22, v22 quad_perm:[1,0,3,2] row_mask:0xf bank_mask:0xf
  v_add_f32_dpp v23, v23, v23 quad_perm:[1,0,3,2] row_mask:0xf bank_mask:0xf
  v_cndmask_b32 v56, v56, v20, s[100:101]
  v_cndmask_b32 v57, v57, v21, s[100:101]
  v_cndmask_b32 v58, v58, v22, s[100:101]
  v_cndmask_b32 v59, v59, v23, s[100:101]
  v_max3_f32 v28, v28, v56, v57
  v_max3_f32 v28, v28, v58, v59
  s_cbranch_vccnz L_sk118
  s_waitcnt vmcnt(4)
L_sk118:
  s_waitcnt vmcnt(5) lgkmcnt(0)
  buffer_load_dwordx4 v[152:155], v1, s[40:43], s7 offen offset:512 nt
  v_cmp_ne_u32 vcc, 0, v31
  v_mfma_f32_16x16x32_bf16 v[12:15], v[128:131], v[4:7], 0
  s_waitcnt vmcnt(4)
  buffer_load_dwordx4 v[156:159], v1, s[40:43], s7 offen offset:640 nt
  v_mfma_f32_16x16x32_bf16 v[12:15], v[132:135], v[8:11], v[12:15]
  v_mfma_f32_16x16x32_bf16 v[16:19], v[136:139], v[4:7], 0
  s_cbranch_vccnz L_sk120
  s_waitcnt vmcnt(4)
L_sk120:
  s_waitcnt vmcnt(5)
  s_add_u32 s7, s7, 32768
  buffer_load_dwordx4 v[160:163], v1, s[40:43], s7 offen offset:0 nt
  s_cbranch_vccnz L_sk121
  s_waitcnt vmcnt(4)
L_sk121:
  s_waitcnt vmcnt(5)
  buffer_load_dwordx4 v[164:167], v1, s[40:43], s7 offen offset:128 nt
  ds_read_b32 v31, v3 offset:9996
  v_mfma_f32_16x16x32_bf16 v[16:19], v[140:143], v[8:11], v[16:19]
  v_cndmask_b32 v20, v12, v13, s[84:85]
  v_cndmask_b32 v21, v14, v15, s[84:85]
  s_nop 5
  v_cndmask_b32 v22, v16, v17, s[84:85]
  v_cndmask_b32 v23, v18, v19, s[84:85]
  v_add_f32_dpp v60, v20, v20 quad_perm:[1,0,3,2] row_mask:0xf bank_mask:0xf
  v_add_f32_dpp v61, v21, v21 quad_perm:[1,0,3,2] row_mask:0xf bank_mask:0xf
  v_add_f32_dpp v62, v22, v22 quad_perm:[1,0,3,2] row_mask:0xf bank_mask:0xf
  v_add_f32_dpp v63, v23, v23 quad_perm:[1,0,3,2] row_mask:0xf bank_mask:0xf
  s_cbranch_vccnz L_sk122
  s_waitcnt vmcnt(4)
L_sk122:
  s_waitcnt vmcnt(5) lgkmcnt(0)
  buffer_load_dwordx4 v[168:171], v1, s[40:43], s7 offen offset:512 nt
  v_cmp_ne_u32 vcc, 0, v31
  v_mfma_f32_16x16x32_bf16 v[12:15], v[144:147], v[4:7], 0
  s_waitcnt vmcnt(4)
  buffer_load_dwordx4 v[172:175], v1, s[40:43], s7 offen offset:640 nt
  v_mfma_f32_16x16x32_bf16 v[12:15], v[148:151], v[8:11], v[12:15]
  v_mfma_f32_16x16x32_bf16 v[16:19], v[152:155], v[4:7], 0
  s_cbranch_vccnz L_sk124
  s_waitcnt vmcnt(4)
L_sk124:
  s_waitcnt vmcnt(5)
  s_add_u32 s7, s7, 32768
  buffer_load_dwordx4 v[176:179], v1, s[40:43], s7 offen offset:0 nt
  s_cbranch_vccnz L_sk125
  s_waitcnt vmcnt(4)
L_sk125:
  s_waitcnt vmcnt(5)
  buffer_load_dwordx4 v[180:183], v1, s[40:43], s7 offen offset:128 nt
  ds_read_b32 v31, v3 offset:9996
  v_mfma_f32_16x16x32_bf16 v[16:19], v[156:159], v[8:11], v[16:19]
  v_cndmask_b32 v20, v12, v13, s[84:85]
  v_cndmask_b32 v21, v14, v15, s[84:85]
  s_nop 5
  v_cndmask_b32 v22, v16, v17, s[84:85]
  v_cndmask_b32 v23, v18, v19, s[84:85]
  v_add_f32_dpp v20, v20, v20 quad_perm:[1,0,3,2] row_mask:0xf bank_mask:0xf
  v_add_f32_dpp v21, v21, v21 quad_perm:[1,0,3,2] row_mask:0xf bank_mask:0xf
  v_add_f32_dpp v22, v22, v22 quad_perm:[1,0,3,2] row_mask:0xf bank_mask:0xf
  v_add_f32_dpp v23, v23, v23 quad_perm:[1,0,3,2] row_mask:0xf bank_mask:0xf
  v_cndmask_b32 v60, v60, v20, s[96:97]
  v_cndmask_b32 v61, v61, v21, s[96:97]
  v_cndmask_b32 v62, v62, v22, s[96:97]
  v_cndmask_b32 v63, v63, v23, s[96:97]
  s_cbranch_vccnz L_sk126
  s_waitcnt vmcnt(4)
L_sk126:
  s_waitcnt vmcnt(5) lgkmcnt(0)
  buffer_load_dwordx4 v[184:187], v1, s[40:43], s7 offen offset:512 nt
  v_cmp_ne_u32 vcc, 0, v31
  v_mfma_f32_16x16x32_bf16 v[12:15], v[160:163], v[4:7], 0
  s_waitcnt vmcnt(4)
  buffer_load_dwordx4 v[188:191], v1, s[40:43], s7 offen offset:640 nt
  v_mfma_f32_16x16x32_bf16 v[12:15], v[164:167], v[8:11], v[12:15]
  v_mfma_f32_16x16x32_bf16 v[16:19], v[168:171], v[4:7], 0
  s_cbranch_vccnz L_sk128
  s_waitcnt vmcnt(4)
L_sk128:
  s_waitcnt vmcnt(5)
  s_sub_u32 s7, s7, 1015808
  buffer_load_dwordx4 v[192:195], v2, s[44:47], s7 offen offset:0 nt
  s_cbranch_vccnz L_sk129
  s_waitcnt vmcnt(4)
L_sk129:
  s_waitcnt vmcnt(5)
  buffer_load_dwordx4 v[196:199], v2, s[44:47], s7 offen offset:256 nt
  ds_read_b32 v31, v3 offset:9996
  v_mfma_f32_16x16x32_bf16 v[16:19], v[172:175], v[8:11], v[16:19]
  v_cndmask_b32 v20, v12, v13, s[84:85]
  v_cndmask_b32 v21, v14, v15, s[84:85]
  s_nop 5
  v_cndmask_b32 v22, v16, v17, s[84:85]
  v_cndmask_b32 v23, v18, v19, s[84:85]
  v_add_f32_dpp v20, v20, v20 quad_perm:[1,0,3,2] row_mask:0xf bank_mask:0xf
  v_add_f32_dpp v21, v21, v21 quad_perm:[1,0,3,2] row_mask:0xf bank_mask:0xf
  v_add_f32_dpp v22, v22, v22 quad_perm:[1,0,3,2] row_mask:0xf bank_mask:0xf
  v_add_f32_dpp v23, v23, v23 quad_perm:[1,0,3,2] row_mask:0xf bank_mask:0xf
  v_cndmask_b32 v60, v60, v20, s[98:99]
  v_cndmask_b32 v61, v61, v21, s[98:99]
  v_cndmask_b32 v62, v62, v22, s[98:99]
  v_cndmask_b32 v63, v63, v23, s[98:99]
  s_cbranch_vccnz L_sk130
  s_waitcnt vmcnt(4)
L_sk130:
  s_waitcnt vmcnt(5) lgkmcnt(0)
  buffer_load_dwordx4 v[200:203], v2, s[44:47], s7 offen offset:512 nt
  v_cmp_ne_u32 vcc, 0, v31
  v_mfma_f32_16x16x32_bf16 v[12:15], v[176:179], v[4:7], 0
  s_waitcnt vmcnt(4)
  buffer_load_dwordx4 v[204:207], v2, s[44:47], s7 offen offset:768 nt
  v_mfma_f32_16x16x32_bf16 v[12:15], v[180:183], v[8:11], v[12:15]
  v_mfma_f32_16x16x32_bf16 v[16:19], v[184:187], v[4:7], 0
  s_cbranch_vccnz L_sk132
  s_waitcnt vmcnt(4)
L_sk132:
  s_waitcnt vmcnt(5)
  s_add_u32 s7, s7, 32768
  buffer_load_dwordx4 v[208:211], v2, s[44:47], s7 offen offset:0 nt
  s_cbranch_vccnz L_sk133
  s_waitcnt vmcnt(4)
L_sk133:
  s_waitcnt vmcnt(5)
  buffer_load_dwordx4 v[212:215], v2, s[44:47], s7 offen offset:256 nt
  ds_read_b32 v31, v3 offset:9996
  v_mfma_f32_16x16x32_bf16 v[16:19], v[188:191], v[8:11], v[16:19]
  v_cndmask_b32 v20, v12, v13, s[84:85]
  v_cndmask_b32 v21, v14, v15, s[84:85]
  s_nop 5
  v_cndmask_b32 v22, v16, v17, s[84:85]
  v_cndmask_b32 v23, v18, v19, s[84:85]
  v_add_f32_dpp v20, v20, v20 quad_perm:[1,0,3,2] row_mask:0xf bank_mask:0xf
  v_add_f32_dpp v21, v21, v21 quad_perm:[1,0,3,2] row_mask:0xf bank_mask:0xf
  v_add_f32_dpp v22, v22, v22 quad_perm:[1,0,3,2] row_mask:0xf bank_mask:0xf
  v_add_f32_dpp v23, v23, v23 quad_perm:[1,0,3,2] row_mask:0xf bank_mask:0xf
  v_cndmask_b32 v60, v60, v20, s[100:101]
  v_cndmask_b32 v61, v61, v21, s[100:101]
  v_cndmask_b32 v62, v62, v22, s[100:101]
  v_cndmask_b32 v63, v63, v23, s[100:101]
  v_max3_f32 v28, v28, v60, v61
  v_max3_f32 v28, v28, v62, v63
  s_nop 1
  v_max_f32_dpp v28, v28, v28 quad_perm:[1,0,3,2] row_mask:0xf bank_mask:0xf
  s_nop 1
  v_max_f32_dpp v28, v28, v28 quad_perm:[2,3,0,1] row_mask:0xf bank_mask:0xf
  v_mov_b32 v29, v28
  s_nop 1
  v_permlane16_swap_b32 v28, v29
  v_max_f32 v28, v28, v29
  v_mov_b32 v29, v28
  s_nop 1
  v_permlane32_swap_b32 v28, v29
  v_max_f32 v28, v28, v29
  v_mul_f32 v24, 0xbe0293ee, v28
  v_fma_f32 v32, v32, s9, v24
  v_fma_f32 v33, v33, s9, v24
  v_fma_f32 v34, v34, s9, v24
  v_fma_f32 v35, v35, s9, v24
  v_exp_f32 v32, v32
  v_exp_f32 v33, v33
  v_exp_f32 v34, v34
  v_exp_f32 v35, v35
  v_add_f32 v20, v32, v33
  v_add_f32 v21, v34, v35
  v_cvt_pk_bf16_f32 v32, v32, v32
  v_cvt_pk_bf16_f32 v33, v33, v33
  v_cvt_pk_bf16_f32 v34, v34, v34
  v_cvt_pk_bf16_f32 v35, v35, v35
  v_add_f32 v25, v20, v21
  v_and_b32_dpp v12, v32, v26 quad_perm:[0,0,0,0] row_mask:0xf bank_mask:0xf
  v_and_b32_dpp v13, v32, v27 quad_perm:[0,0,0,0] row_mask:0xf bank_mask:0xf
  v_and_b32_dpp v14, v33, v26 quad_perm:[0,0,0,0] row_mask:0xf bank_mask:0xf
  v_and_b32_dpp v15, v33, v27 quad_perm:[0,0,0,0] row_mask:0xf bank_mask:0xf
  s_cbranch_vccnz L_sk134
  s_waitcnt vmcnt(4)
L_sk134:
  s_waitcnt vmcnt(5) lgkmcnt(0)
  buffer_load_dwordx4 v[216:219], v2, s[44:47], s7 offen offset:512 nt
  v_cmp_ne_u32 vcc, 0, v31
  v_mfma_f32_16x16x16_bf16 v[4:7], v[12:13], v[192:193], 0
  v_mfma_f32_16x16x16_bf16 v[8:11], v[12:13], v[194:195], 0
  v_and_b32_dpp v16, v34, v26 quad_perm:[0,0,0,0] row_mask:0xf bank_mask:0xf
  v_and_b32_dpp v17, v34, v27 quad_perm:[0,0,0,0] row_mask:0xf bank_mask:0xf
  s_waitcnt vmcnt(4)
  buffer_load_dwordx4 v[220:223], v2, s[44:47], s7 offen offset:768 nt
  v_mfma_f32_16x16x16_bf16 v[4:7], v[14:15], v[196:197], v[4:7]
  v_mfma_f32_16x16x16_bf16 v[8:11], v[14:15], v[198:199], v[8:11]
  v_and_b32_dpp v18, v35, v26 quad_perm:[0,0,0,0] row_mask:0xf bank_mask:0xf
  v_and_b32_dpp v19, v35, v27 quad_perm:[0,0,0,0] row_mask:0xf bank_mask:0xf
  v_mfma_f32_16x16x16_bf16 v[4:7], v[16:17], v[200:201], v[4:7]
  v_mfma_f32_16x16x16_bf16 v[8:11], v[16:17], v[202:203], v[8:11]
  v_and_b32_dpp v12, v32, v26 quad_perm:[1,1,1,1] row_mask:0xf bank_mask:0xf
  v_and_b32_dpp v13, v32, v27 quad_perm:[1,1,1,1] row_mask:0xf bank_mask:0xf
  s_cbranch_vccnz L_sk136
  s_waitcnt vmcnt(4)
L_sk136:
  s_waitcnt vmcnt(5)
  s_add_u32 s7, s7, 32768
  buffer_load_dwordx4 v[224:227], v2, s[44:47], s7 offen offset:0 nt
  s_cbranch_vccnz L_sk137
  s_waitcnt vmcnt(4)
L_sk137:
  s_waitcnt vmcnt(5)
  buffer_load_dwordx4 v[228:231], v2, s[44:47], s7 offen offset:256 nt
  ds_read_b32 v31, v3 offset:9996
  v_mfma_f32_16x16x16_bf16 v[4:7], v[18:19], v[204:205], v[4:7]
  v_mfma_f32_16x16x16_bf16 v[8:11], v[18:19], v[206:207], v[8:11]
  v_and_b32_dpp v14, v33, v26 quad_perm:[1,1,1,1] row_mask:0xf bank_mask:0xf
  v_and_b32_dpp v15, v33, v27 quad_perm:[1,1,1,1] row_mask:0xf bank_mask:0xf
  s_cbranch_vccnz L_sk138
  s_waitcnt vmcnt(4)
L_sk138:
  s_waitcnt vmcnt(5) lgkmcnt(0)
  buffer_load_dwordx4 v[232:235], v2, s[44:47], s7 offen offset:512 nt
  v_cmp_ne_u32 vcc, 0, v31
  v_mfma_f32_16x16x16_bf16 v[4:7], v[12:13], v[208:209], v[4:7]
  v_mfma_f32_16x16x16_bf16 v[8:11], v[12:13], v[210:211], v[8:11]
  v_and_b32_dpp v16, v34, v26 quad_perm:[1,1,1,1] row_mask:0xf bank_mask:0xf
  v_and_b32_dpp v17, v34, v27 quad_perm:[1,1,1,1] row_mask:0xf bank_mask:0xf
  s_waitcnt vmcnt(4)
  buffer_load_dwordx4 v[236:239], v2, s[44:47], s7 offen offset:768 nt
  v_mfma_f32_16x16x16_bf16 v[4:7], v[14:15], v[212:213], v[4:7]
  v_mfma_f32_16x16x16_bf16 v[8:11], v[14:15], v[214:215], v[8:11]
  v_and_b32_dpp v18, v35, v26 quad_perm:[1,1,1,1] row_mask:0xf bank_mask:0xf
  v_and_b32_dpp v19, v35, v27 quad_perm:[1,1,1,1] row_mask:0xf bank_mask:0xf
  v_mfma_f32_16x16x16_bf16 v[4:7], v[16:17], v[216:217], v[4:7]
  v_mfma_f32_16x16x16_bf16 v[8:11], v[16:17], v[218:219], v[8:11]
  v_and_b32_dpp v12, v32, v26 quad_perm:[2,2,2,2] row_mask:0xf bank_mask:0xf
  v_and_b32_dpp v13, v32, v27 quad_perm:[2,2,2,2] row_mask:0xf bank_mask:0xf
  s_cbranch_vccnz L_sk140
  s_waitcnt vmcnt(4)
L_sk140:
  s_waitcnt vmcnt(5)
  s_add_u32 s7, s7, 32768
  buffer_load_dwordx4 v[240:243], v2, s[44:47], s7 offen offset:0 nt
  s_cbranch_vccnz L_sk141
  s_waitcnt vmcnt(4)
L_sk141:
  s_waitcnt vmcnt(5)
  buffer_load_dwordx4 v[244:247], v2, s[44:47], s7 offen offset:256 nt
  ds_read_b32 v31, v3 offset:9996
  v_mfma_f32_16x16x16_bf16 v[4:7], v[18:19], v[220:221], v[4:7]
  v_mfma_f32_16x16x16_bf16 v[8:11], v[18:19], v[222:223], v[8:11]
  v_and_b32_dpp v14, v33, v26 quad_perm:[2,2,2,2] row_mask:0xf bank_mask:0xf
  v_and_b32_dpp v15, v33, v27 quad_perm:[2,2,2,2] row_mask:0xf bank_mask:0xf
  s_cbranch_vccnz L_sk142
  s_waitcnt vmcnt(4)
L_sk142:
  s_waitcnt vmcnt(5) lgkmcnt(0)
  buffer_load_dwordx4 v[248:251], v2, s[44:47], s7 offen offset:512 nt
  v_cmp_ne_u32 vcc, 0, v31
  v_mfma_f32_16x16x16_bf16 v[4:7], v[12:13], v[224:225], v[4:7]
  v_mfma_f32_16x16x16_bf16 v[8:11], v[12:13], v[226:227], v[8:11]
  v_fma_f32 v36, v36, s9, v24
  v_fma_f32 v37, v37, s9, v24
  v_fma_f32 v38, v38, s9, v24
  v_fma_f32 v39, v39, s9, v24
  v_exp_f32 v36, v36
  v_exp_f32 v37, v37
  v_exp_f32 v38, v38
  v_exp_f32 v39, v39
  v_add_f32 v20, v36, v37
  v_add_f32 v21, v38, v39
  v_cvt_pk_bf16_f32 v36, v36, v36
  v_cvt_pk_bf16_f32 v37, v37, v37
  v_cvt_pk_bf16_f32 v38, v38, v38
  v_cvt_pk_bf16_f32 v39, v39, v39
  v_add_f32 v20, v20, v21
  v_add_f32 v25, v25, v20
  v_and_b32_dpp v16, v34, v26 quad_perm:[2,2,2,2] row_mask:0xf bank_mask:0xf
  v_and_b32_dpp v17, v34, v27 quad_perm:[2,2,2,2] row_mask:0xf bank_mask:0xf
  s_waitcnt vmcnt(4)
  buffer_load_dwordx4 v[252:255], v2, s[44:47], s7 offen offset:768 nt
  v_mfma_f32_16x16x16_bf16 v[4:7], v[14:15], v[228:229], v[4:7]
  v_mfma_f32_16x16x16_bf16 v[8:11], v[14:15], v[230:231], v[8:11]
  v_and_b32_dpp v18, v35, v26 quad_perm:[2,2,2,2] row_mask:0xf bank_mask:0xf
  v_and_b32_dpp v19, v35, v27 quad_perm:[2,2,2,2] row_mask:0xf bank_mask:0xf
  v_mfma_f32_16x16x16_bf16 v[4:7], v[16:17], v[232:233], v[4:7]
  v_mfma_f32_16x16x16_bf16 v[8:11], v[16:17], v[234:235], v[8:11]
  v_and_b32_dpp v12, v32, v26 quad_perm:[3,3,3,3] row_mask:0xf bank_mask:0xf
  v_and_b32_dpp v13, v32, v27 quad_perm:[3,3,3,3] row_mask:0xf bank_mask:0xf
  s_cbranch_vccnz L_sk144
  s_waitcnt vmcnt(4)
L_sk144:
  s_waitcnt vmcnt(5)
  s_add_u32 s7, s7, 32768
  buffer_load_dwordx4 v[64:67], v2, s[44:47], s7 offen offset:0 nt
  s_cbranch_vccnz L_sk145
  s_waitcnt vmcnt(4)
L_sk145:
  s_waitcnt vmcnt(5)
  buffer_load_dwordx4 v[68:71], v2, s[44:47], s7 offen offset:256 nt
  ds_read_b32 v31, v3 offset:9996
  v_mfma_f32_16x16x16_bf16 v[4:7], v[18:19], v[236:237], v[4:7]
  v_mfma_f32_16x16x16_bf16 v[8:11], v[18:19], v[238:239], v[8:11]
  v_and_b32_dpp v14, v33, v26 quad_perm:[3,3,3,3] row_mask:0xf bank_mask:0xf
  v_and_b32_dpp v15, v33, v27 quad_perm:[3,3,3,3] row_mask:0xf bank_mask:0xf
  s_cbranch_vccnz L_sk146
  s_waitcnt vmcnt(4)
L_sk146:
  s_waitcnt vmcnt(5) lgkmcnt(0)
  buffer_load_dwordx4 v[72:75], v2, s[44:47], s7 offen offset:512 nt
  v_cmp_ne_u32 vcc, 0, v31
  v_mfma_f32_16x16x16_bf16 v[4:7], v[12:13], v[240:241], v[4:7]
  v_mfma_f32_16x16x16_bf16 v[8:11], v[12:13], v[242:243], v[8:11]
  v_and_b32_dpp v16, v34, v26 quad_perm:[3,3,3,3] row_mask:0xf bank_mask:0xf
  v_and_b32_dpp v17, v34, v27 quad_perm:[3,3,3,3] row_mask:0xf bank_mask:0xf
  s_waitcnt vmcnt(4)
  buffer_load_dwordx4 v[76:79], v2, s[44:47], s7 offen offset:768 nt
  v_mfma_f32_16x16x16_bf16 v[4:7], v[14:15], v[244:245], v[4:7]
  v_mfma_f32_16x16x16_bf16 v[8:11], v[14:15], v[246:247], v[8:11]
  v_and_b32_dpp v18, v35, v26 quad_perm:[3,3,3,3] row_mask:0xf bank_mask:0xf
  v_and_b32_dpp v19, v35, v27 quad_perm:[3,3,3,3] row_mask:0xf bank_mask:0xf
  v_mfma_f32_16x16x16_bf16 v[4:7], v[16:17], v[248:249], v[4:7]
  v_mfma_f32_16x16x16_bf16 v[8:11], v[16:17], v[250:251], v[8:11]
  v_and_b32_dpp v12, v36, v26 quad_perm:[0,0,0,0] row_mask:0xf bank_mask:0xf
  v_and_b32_dpp v13, v36, v27 quad_perm:[0,0,0,0] row_mask:0xf bank_mask:0xf
  s_cbranch_vccnz L_sk148
  s_waitcnt vmcnt(4)
L_sk148:
  s_waitcnt vmcnt(5)
  s_add_u32 s7, s7, 32768
  buffer_load_dwordx4 v[80:83], v2, s[44:47], s7 offen offset:0 nt
  s_cbranch_vccnz L_sk149
  s_waitcnt vmcnt(4)
L_sk149:
  s_waitcnt vmcnt(5)
  buffer_load_dwordx4 v[84:87], v2, s[44:47], s7 offen offset:256 nt
  ds_read_b32 v31, v3 offset:9996
  v_mfma_f32_16x16x16_bf16 v[4:7], v[18:19], v[252:253], v[4:7]
  v_mfma_f32_16x16x16_bf16 v[8:11], v[18:19], v[254:255], v[8:11]
  v_and_b32_dpp v14, v37, v26 quad_perm:[0,0,0,0] row_mask:0xf bank_mask:0xf
  v_and_b32_dpp v15, v37, v27 quad_perm:[0,0,0,0] row_mask:0xf bank_mask:0xf
  s_cbranch_vccnz L_sk150
  s_waitcnt vmcnt(4)
L_sk150:
  s_waitcnt vmcnt(5) lgkmcnt(0)
  buffer_load_dwordx4 v[88:91], v2, s[44:47], s7 offen offset:512 nt
  v_cmp_ne_u32 vcc, 0, v31
  v_mfma_f32_16x16x16_bf16 v[4:7], v[12:13], v[64:65], v[4:7]
  v_mfma_f32_16x16x16_bf16 v[8:11], v[12:13], v[66:67], v[8:11]
  v_and_b32_dpp v16, v38, v26 quad_perm:[0,0,0,0] row_mask:0xf bank_mask:0xf
  v_and_b32_dpp v17, v38, v27 quad_perm:[0,0,0,0] row_mask:0xf bank_mask:0xf
  s_waitcnt vmcnt(4)
  buffer_load_dwordx4 v[92:95], v2, s[44:47], s7 offen offset:768 nt
  v_mfma_f32_16x16x16_bf16 v[4:7], v[14:15], v[68:69], v[4:7]
  v_mfma_f32_16x16x16_bf16 v[8:11], v[14:15], v[70:71], v[8:11]
  v_and_b32_dpp v18, v39, v26 quad_perm:[0,0,0,0] row_mask:0xf bank_mask:0xf
  v_and_b32_dpp v19, v39, v27 quad_perm:[0,0,0,0] row_mask:0xf bank_mask:0xf
  v_mfma_f32_16x16x16_bf16 v[4:7], v[16:17], v[72:73], v[4:7]
  v_mfma_f32_16x16x16_bf16 v[8:11], v[16:17], v[74:75], v[8:11]
  v_and_b32_dpp v12, v36, v26 quad_perm:[1,1,1,1] row_mask:0xf bank_mask:0xf
  v_and_b32_dpp v13, v36, v27 quad_perm:[1,1,1,1] row_mask:0xf bank_mask:0xf
  s_cbranch_vccnz L_sk152
  s_waitcnt vmcnt(4)
L_sk152:
  s_waitcnt vmcnt(5)
  s_add_u32 s7, s7, 32768
  buffer_load_dwordx4 v[96:99], v2, s[44:47], s7 offen offset:0 nt
  s_cbranch_vccnz L_sk153
  s_waitcnt vmcnt(4)
L_sk153:
  s_waitcnt vmcnt(5)
  buffer_load_dwordx4 v[100:103], v2, s[44:47], s7 offen offset:256 nt
  ds_read_b32 v31, v3 offset:9996
  v_mfma_f32_16x16x16_bf16 v[4:7], v[18:19], v[76:77], v[4:7]
  v_mfma_f32_16x16x16_bf16 v[8:11], v[18:19], v[78:79], v[8:11]
  v_and_b32_dpp v14, v37, v26 quad_perm:[1,1,1,1] row_mask:0xf bank_mask:0xf
  v_and_b32_dpp v15, v37, v27 quad_perm:[1,1,1,1] row_mask:0xf bank_mask:0xf
  s_cbranch_vccnz L_sk154
  s_waitcnt vmcnt(4)
L_sk154:
  s_waitcnt vmcnt(5) lgkmcnt(0)
  buffer_load_dwordx4 v[104:107], v2, s[44:47], s7 offen offset:512 nt
  v_cmp_ne_u32 vcc, 0, v31
  v_mfma_f32_16x16x16_bf16 v[4:7], v[12:13], v[80:81], v[4:7]
  v_mfma_f32_16x16x16_bf16 v[8:11], v[12:13], v[82:83], v[8:11]
  v_and_b32_dpp v16, v38, v26 quad_perm:[1,1,1,1] row_mask:0xf bank_mask:0xf
  v_and_b32_dpp v17, v38, v27 quad_perm:[1,1,1,1] row_mask:0xf bank_mask:0xf
  s_waitcnt vmcnt(4)
  buffer_load_dwordx4 v[108:111], v2, s[44:47], s7 offen offset:768 nt
  v_mfma_f32_16x16x16_bf16 v[4:7], v[14:15], v[84:85], v[4:7]
  v_mfma_f32_16x16x16_bf16 v[8:11], v[14:15], v[86:87], v[8:11]
  v_and_b32_dpp v18, v39, v26 quad_perm:[1,1,1,1] row_mask:0xf bank_mask:0xf
  v_and_b32_dpp v19, v39, v27 quad_perm:[1,1,1,1] row_mask:0xf bank_mask:0xf
  v_mfma_f32_16x16x16_bf16 v[4:7], v[16:17], v[88:89], v[4:7]
  v_mfma_f32_16x16x16_bf16 v[8:11], v[16:17], v[90:91], v[8:11]
  v_and_b32_dpp v12, v36, v26 quad_perm:[2,2,2,2] row_mask:0xf bank_mask:0xf
  v_and_b32_dpp v13, v36, v27 quad_perm:[2,2,2,2] row_mask:0xf bank_mask:0xf
  s_cbranch_vccnz L_sk156
  s_waitcnt vmcnt(4)
L_sk156:
  s_waitcnt vmcnt(5)
  s_add_u32 s7, s7, 32768
  buffer_load_dwordx4 v[112:115], v2, s[44:47], s7 offen offset:0 nt
  s_cbranch_vccnz L_sk157
  s_waitcnt vmcnt(4)
L_sk157:
  s_waitcnt vmcnt(5)
  buffer_load_dwordx4 v[116:119], v2, s[44:47], s7 offen offset:256 nt
  ds_read_b32 v31, v3 offset:9996
  v_mfma_f32_16x16x16_bf16 v[4:7], v[18:19], v[92:93], v[4:7]
  v_mfma_f32_16x16x16_bf16 v[8:11], v[18:19], v[94:95], v[8:11]
  v_and_b32_dpp v14, v37, v26 quad_perm:[2,2,2,2] row_mask:0xf bank_mask:0xf
  v_and_b32_dpp v15, v37, v27 quad_perm:[2,2,2,2] row_mask:0xf bank_mask:0xf
  s_cbranch_vccnz L_sk158
  s_waitcnt vmcnt(4)
L_sk158:
  s_waitcnt vmcnt(5) lgkmcnt(0)
  buffer_load_dwordx4 v[120:123], v2, s[44:47], s7 offen offset:512 nt
  v_cmp_ne_u32 vcc, 0, v31
  v_mfma_f32_16x16x16_bf16 v[4:7], v[12:13], v[96:97], v[4:7]
  v_mfma_f32_16x16x16_bf16 v[8:11], v[12:13], v[98:99], v[8:11]
  v_fma_f32 v40, v40, s9, v24
  v_fma_f32 v41, v41, s9, v24
  v_fma_f32 v42, v42, s9, v24
  v_fma_f32 v43, v43, s9, v24
  v_exp_f32 v40, v40
  v_exp_f32 v41, v41
  v_exp_f32 v42, v42
  v_exp_f32 v43, v43
  v_add_f32 v20, v40, v41
  v_add_f32 v21, v42, v43
  v_cvt_pk_bf16_f32 v40, v40, v40
  v_cvt_pk_bf16_f32 v41, v41, v41
  v_cvt_pk_bf16_f32 v42, v42, v42
  v_cvt_pk_bf16_f32 v43, v43, v43
  v_add_f32 v20, v20, v21
  v_add_f32 v25, v25, v20
  v_and_b32_dpp v16, v38, v26 quad_perm:[2,2,2,2] row_mask:0xf bank_mask:0xf
  v_and_b32_dpp v17, v38, v27 quad_perm:[2,2,2,2] row_mask:0xf bank_mask:0xf
  s_waitcnt vmcnt(4)
  buffer_load_dwordx4 v[124:127], v2, s[44:47], s7 offen offset:768 nt
  v_mfma_f32_16x16x16_bf16 v[4:7], v[14:15], v[100:101], v[4:7]
  v_mfma_f32_16x16x16_bf16 v[8:11], v[14:15], v[102:103], v[8:11]
  v_and_b32_dpp v18, v39, v26 quad_perm:[2,2,2,2] row_mask:0xf bank_mask:0xf
  v_and_b32_dpp v19, v39, v27 quad_perm:[2,2,2,2] row_mask:0xf bank_mask:0xf
  v_mfma_f32_16x16x16_bf16 v[4:7], v[16:17], v[104:105], v[4:7]
  v_mfma_f32_16x16x16_bf16 v[8:11], v[16:17], v[106:107], v[8:11]
  v_and_b32_dpp v12, v36, v26 quad_perm:[3,3,3,3] row_mask:0xf bank_mask:0xf
  v_and_b32_dpp v13, v36, v27 quad_perm:[3,3,3,3] row_mask:0xf bank_mask:0xf
  s_cbranch_vccnz L_sk160
  s_waitcnt vmcnt(4)
L_sk160:
  s_waitcnt vmcnt(5)
  s_add_u32 s7, s7, 32768
  buffer_load_dwordx4 v[128:131], v2, s[44:47], s7 offen offset:0 nt
  ds_add_u32 v3, v30 offset:10000
  s_cbranch_vccnz L_sk161
  s_waitcnt vmcnt(4)
L_sk161:
  s_waitcnt vmcnt(5)
  buffer_load_dwordx4 v[132:135], v2, s[44:47], s7 offen offset:256 nt
  ds_read_b32 v31, v3 offset:9996
  v_mfma_f32_16x16x16_bf16 v[4:7], v[18:19], v[108:109], v[4:7]
  v_mfma_f32_16x16x16_bf16 v[8:11], v[18:19], v[110:111], v[8:11]
  v_and_b32_dpp v14, v37, v26 quad_perm:[3,3,3,3] row_mask:0xf bank_mask:0xf
  v_and_b32_dpp v15, v37, v27 quad_perm:[3,3,3,3] row_mask:0xf bank_mask:0xf
  s_cbranch_vccnz L_sk162
  s_waitcnt vmcnt(4)
L_sk162:
  s_waitcnt vmcnt(5) lgkmcnt(0)
  buffer_load_dwordx4 v[136:139], v2, s[44:47], s7 offen offset:512 nt
  v_cmp_ne_u32 vcc, 0, v31
  v_mfma_f32_16x16x16_bf16 v[4:7], v[12:13], v[112:113], v[4:7]
  v_mfma_f32_16x16x16_bf16 v[8:11], v[12:13], v[114:115], v[8:11]
  v_and_b32_dpp v16, v38, v26 quad_perm:[3,3,3,3] row_mask:0xf bank_mask:0xf
  v_and_b32_dpp v17, v38, v27 quad_perm:[3,3,3,3] row_mask:0xf bank_mask:0xf
  s_waitcnt vmcnt(4)
  buffer_load_dwordx4 v[140:143], v2, s[44:47], s7 offen offset:768 nt
  v_mfma_f32_16x16x16_bf16 v[4:7], v[14:15], v[116:117], v[4:7]
  v_mfma_f32_16x16x16_bf16 v[8:11], v[14:15], v[118:119], v[8:11]
  v_and_b32_dpp v18, v39, v26 quad_perm:[3,3,3,3] row_mask:0xf bank_mask:0xf
  v_and_b32_dpp v19, v39, v27 quad_perm:[3,3,3,3] row_mask:0xf bank_mask:0xf
  v_mfma_f32_16x16x16_bf16 v[4:7], v[16:17], v[120:121], v[4:7]
  v_mfma_f32_16x16x16_bf16 v[8:11], v[16:17], v[122:123], v[8:11]
  v_and_b32_dpp v12, v40, v26 quad_perm:[0,0,0,0] row_mask:0xf bank_mask:0xf
  v_and_b32_dpp v13, v40, v27 quad_perm:[0,0,0,0] row_mask:0xf bank_mask:0xf
  s_cbranch_vccnz L_sk164
  s_waitcnt vmcnt(4)
L_sk164:
  s_waitcnt vmcnt(5)
  s_add_u32 s7, s7, 32768
  buffer_load_dwordx4 v[144:147], v2, s[44:47], s7 offen offset:0 nt
  s_cbranch_vccnz L_sk165
  s_waitcnt vmcnt(4)
L_sk165:
  s_waitcnt vmcnt(5)
  buffer_load_dwordx4 v[148:151], v2, s[44:47], s7 offen offset:256 nt
  ds_read_b32 v31, v3 offset:9996
  v_mfma_f32_16x16x16_bf16 v[4:7], v[18:19], v[124:125], v[4:7]
  v_mfma_f32_16x16x16_bf16 v[8:11], v[18:19], v[126:127], v[8:11]
  v_and_b32_dpp v14, v41, v26 quad_perm:[0,0,0,0] row_mask:0xf bank_mask:0xf
  v_and_b32_dpp v15, v41, v27 quad_perm:[0,0,0,0] row_mask:0xf bank_mask:0xf
  s_cbranch_vccnz L_sk166
  s_waitcnt vmcnt(4)
L_sk166:
  s_waitcnt vmcnt(5) lgkmcnt(0)
  buffer_load_dwordx4 v[152:155], v2, s[44:47], s7 offen offset:512 nt
  v_cmp_ne_u32 vcc, 0, v31
  v_mfma_f32_16x16x16_bf16 v[4:7], v[12:13], v[128:129], v[4:7]
  v_mfma_f32_16x16x16_bf16 v[8:11], v[12:13], v[130:131], v[8:11]
  v_and_b32_dpp v16, v42, v26 quad_perm:[0,0,0,0] row_mask:0xf bank_mask:0xf
  v_and_b32_dpp v17, v42, v27 quad_perm:[0,0,0,0] row_mask:0xf bank_mask:0xf
  s_waitcnt vmcnt(4)
  buffer_load_dwordx4 v[156:159], v2, s[44:47], s7 offen offset:768 nt
  v_mfma_f32_16x16x16_bf16 v[4:7], v[14:15], v[132:133], v[4:7]
  v_mfma_f32_16x16x16_bf16 v[8:11], v[14:15], v[134:135], v[8:11]
  v_and_b32_dpp v18, v43, v26 quad_perm:[0,0,0,0] row_mask:0xf bank_mask:0xf
  v_and_b32_dpp v19, v43, v27 quad_perm:[0,0,0,0] row_mask:0xf bank_mask:0xf
  v_mfma_f32_16x16x16_bf16 v[4:7], v[16:17], v[136:137], v[4:7]
  v_mfma_f32_16x16x16_bf16 v[8:11], v[16:17], v[138:139], v[8:11]
  v_and_b32_dpp v12, v40, v26 quad_perm:[1,1,1,1] row_mask:0xf bank_mask:0xf
  v_and_b32_dpp v13, v40, v27 quad_perm:[1,1,1,1] row_mask:0xf bank_mask:0xf
  s_cbranch_vccnz L_sk168
  s_waitcnt vmcnt(4)
L_sk168:
  s_waitcnt vmcnt(5)
  s_add_u32 s7, s7, 32768
  buffer_load_dwordx4 v[160:163], v2, s[44:47], s7 offen offset:0 nt
  s_cbranch_vccnz L_sk169
  s_waitcnt vmcnt(4)
L_sk169:
  s_waitcnt vmcnt(5)
  buffer_load_dwordx4 v[164:167], v2, s[44:47], s7 offen offset:256 nt
  ds_read_b32 v31, v3 offset:9996
  v_mfma_f32_16x16x16_bf16 v[4:7], v[18:19], v[140:141], v[4:7]
  v_mfma_f32_16x16x16_bf16 v[8:11], v[18:19], v[142:143], v[8:11]
  v_and_b32_dpp v14, v41, v26 quad_perm:[1,1,1,1] row_mask:0xf bank_mask:0xf
  v_and_b32_dpp v15, v41, v27 quad_perm:[1,1,1,1] row_mask:0xf bank_mask:0xf
  s_cbranch_vccnz L_sk170
  s_waitcnt vmcnt(4)
L_sk170:
  s_waitcnt vmcnt(5) lgkmcnt(0)
  buffer_load_dwordx4 v[168:171], v2, s[44:47], s7 offen offset:512 nt
  v_cmp_ne_u32 vcc, 0, v31
  v_mfma_f32_16x16x16_bf16 v[4:7], v[12:13], v[144:145], v[4:7]
  v_mfma_f32_16x16x16_bf16 v[8:11], v[12:13], v[146:147], v[8:11]
  v_and_b32_dpp v16, v42, v26 quad_perm:[1,1,1,1] row_mask:0xf bank_mask:0xf
  v_and_b32_dpp v17, v42, v27 quad_perm:[1,1,1,1] row_mask:0xf bank_mask:0xf
  s_lshl_b32 s11, s4, 16
  s_lshl_b32 s8, s5, 8
  s_add_u32 s11, s11, s8
  s_add_u32 s11, s11, 524288
  v_lshrrev_b32 v32, 3, v0
  v_lshlrev_b32 v32, 13, v32
  v_and_b32 v33, 7, v0
  v_lshl_add_u32 v32, v33, 4, v32
  v_add_u32 v32, s11, v32
  s_lshl_b32 s10, s4, 11
  s_lshl_b32 s8, s5, 4
  s_add_u32 s10, s10, s8
  s_add_u32 s10, s10, 196608
  v_lshrrev_b32 v34, 4, v0
  v_lshlrev_b32 v33, 9, v34
  v_add_u32 v33, s10, v33
  v_lshlrev_b32 v34, 5, v34
  v_lshlrev_b32 v35, 4, v0
  s_lshl_b32 s10, s3, 11
  v_add_u32 v36, s10, v35
  v_mov_b32 v37, 0
  v_mov_b32 v38, 1
  v_mov_b32 v39, 0xff
  s_waitcnt vmcnt(4)
  buffer_load_dwordx4 v[172:175], v2, s[44:47], s7 offen offset:768 nt
  v_mfma_f32_16x16x16_bf16 v[4:7], v[14:15], v[148:149], v[4:7]
  v_mfma_f32_16x16x16_bf16 v[8:11], v[14:15], v[150:151], v[8:11]
  v_and_b32_dpp v18, v43, v26 quad_perm:[1,1,1,1] row_mask:0xf bank_mask:0xf
  v_and_b32_dpp v19, v43, v27 quad_perm:[1,1,1,1] row_mask:0xf bank_mask:0xf
  v_mfma_f32_16x16x16_bf16 v[4:7], v[16:17], v[152:153], v[4:7]
  v_mfma_f32_16x16x16_bf16 v[8:11], v[16:17], v[154:155], v[8:11]
  v_and_b32_dpp v12, v40, v26 quad_perm:[2,2,2,2] row_mask:0xf bank_mask:0xf
  v_and_b32_dpp v13, v40, v27 quad_perm:[2,2,2,2] row_mask:0xf bank_mask:0xf
  s_cbranch_vccnz L_sk172
  s_waitcnt vmcnt(4)
L_sk172:
  s_waitcnt vmcnt(5)
  s_add_u32 s7, s7, 32768
  buffer_load_dwordx4 v[176:179], v2, s[44:47], s7 offen offset:0 nt
  s_cbranch_vccnz L_sk173
  s_waitcnt vmcnt(4)
L_sk173:
  s_waitcnt vmcnt(5)
  buffer_load_dwordx4 v[180:183], v2, s[44:47], s7 offen offset:256 nt
  ds_read_b32 v31, v3 offset:9996
  v_mfma_f32_16x16x16_bf16 v[4:7], v[18:19], v[156:157], v[4:7]
  v_mfma_f32_16x16x16_bf16 v[8:11], v[18:19], v[158:159], v[8:11]
  v_and_b32_dpp v14, v41, v26 quad_perm:[2,2,2,2] row_mask:0xf bank_mask:0xf
  v_and_b32_dpp v15, v41, v27 quad_perm:[2,2,2,2] row_mask:0xf bank_mask:0xf
  s_cbranch_vccnz L_sk174
  s_waitcnt vmcnt(4)
L_sk174:
  s_waitcnt vmcnt(5) lgkmcnt(0)
  buffer_load_dwordx4 v[184:187], v2, s[44:47], s7 offen offset:512 nt
  v_cmp_ne_u32 vcc, 0, v31
  v_mfma_f32_16x16x16_bf16 v[4:7], v[12:13], v[160:161], v[4:7]
  v_mfma_f32_16x16x16_bf16 v[8:11], v[12:13], v[162:163], v[8:11]
  v_fma_f32 v44, v44, s9, v24
  v_fma_f32 v45, v45, s9, v24
  v_fma_f32 v46, v46, s9, v24
  v_fma_f32 v47, v47, s9, v24
  v_exp_f32 v44, v44
  v_exp_f32 v45, v45
  v_exp_f32 v46, v46
  v_exp_f32 v47, v47
  v_add_f32 v20, v44, v45
  v_add_f32 v21, v46, v47
  v_cvt_pk_bf16_f32 v44, v44, v44
  v_cvt_pk_bf16_f32 v45, v45, v45
  v_cvt_pk_bf16_f32 v46, v46, v46
  v_cvt_pk_bf16_f32 v47, v47, v47
  v_add_f32 v20, v20, v21
  v_add_f32 v25, v25, v20
  v_and_b32_dpp v16, v42, v26 quad_perm:[2,2,2,2] row_mask:0xf bank_mask:0xf
  v_and_b32_dpp v17, v42, v27 quad_perm:[2,2,2,2] row_mask:0xf bank_mask:0xf
  s_waitcnt vmcnt(4)
  buffer_load_dwordx4 v[188:191], v2, s[44:47], s7 offen offset:768 nt
  v_mfma_f32_16x16x16_bf16 v[4:7], v[14:15], v[164:165], v[4:7]
  v_mfma_f32_16x16x16_bf16 v[8:11], v[14:15], v[166:167], v[8:11]
  v_and_b32_dpp v18, v43, v26 quad_perm:[2,2,2,2] row_mask:0xf bank_mask:0xf
  v_and_b32_dpp v19, v43, v27 quad_perm:[2,2,2,2] row_mask:0xf bank_mask:0xf
  v_mfma_f32_16x16x16_bf16 v[4:7], v[16:17], v[168:169], v[4:7]
  v_mfma_f32_16x16x16_bf16 v[8:11], v[16:17], v[170:171], v[8:11]
  v_and_b32_dpp v12, v40, v26 quad_perm:[3,3,3,3] row_mask:0xf bank_mask:0xf
  v_and_b32_dpp v13, v40, v27 quad_perm:[3,3,3,3] row_mask:0xf bank_mask:0xf
  s_cbranch_vccnz L_sk176
  s_waitcnt vmcnt(4)
L_sk176:
  s_waitcnt vmcnt(5)
  s_add_u32 s7, s7, 32768
  buffer_load_dwordx4 v[192:195], v2, s[44:47], s7 offen offset:0 nt
  s_cbranch_vccnz L_sk177
  s_waitcnt vmcnt(4)
L_sk177:
  s_waitcnt vmcnt(5)
  buffer_load_dwordx4 v[196:199], v2, s[44:47], s7 offen offset:256 nt
  ds_read_b32 v31, v3 offset:9996
  v_mfma_f32_16x16x16_bf16 v[4:7], v[18:19], v[172:173], v[4:7]
  v_mfma_f32_16x16x16_bf16 v[8:11], v[18:19], v[174:175], v[8:11]
  v_and_b32_dpp v14, v41, v26 quad_perm:[3,3,3,3] row_mask:0xf bank_mask:0xf
  v_and_b32_dpp v15, v41, v27 quad_perm:[3,3,3,3] row_mask:0xf bank_mask:0xf
  s_cbranch_vccnz L_sk178
  s_waitcnt vmcnt(4)
L_sk178:
  s_waitcnt vmcnt(5) lgkmcnt(0)
  buffer_load_dwordx4 v[200:203], v2, s[44:47], s7 offen offset:512 nt
  v_cmp_ne_u32 vcc, 0, v31
  v_mfma_f32_16x16x16_bf16 v[4:7], v[12:13], v[176:177], v[4:7]
  v_mfma_f32_16x16x16_bf16 v[8:11], v[12:13], v[178:179], v[8:11]
  v_and_b32_dpp v16, v42, v26 quad_perm:[3,3,3,3] row_mask:0xf bank_mask:0xf
  v_and_b32_dpp v17, v42, v27 quad_perm:[3,3,3,3] row_mask:0xf bank_mask:0xf
  s_waitcnt vmcnt(4)
  buffer_load_dwordx4 v[204:207], v2, s[44:47], s7 offen offset:768 nt
  v_mfma_f32_16x16x16_bf16 v[4:7], v[14:15], v[180:181], v[4:7]
  v_mfma_f32_16x16x16_bf16 v[8:11], v[14:15], v[182:183], v[8:11]
  v_and_b32_dpp v18, v43, v26 quad_perm:[3,3,3,3] row_mask:0xf bank_mask:0xf
  v_and_b32_dpp v19, v43, v27 quad_perm:[3,3,3,3] row_mask:0xf bank_mask:0xf
  v_mfma_f32_16x16x16_bf16 v[4:7], v[16:17], v[184:185], v[4:7]
  v_mfma_f32_16x16x16_bf16 v[8:11], v[16:17], v[186:187], v[8:11]
  v_and_b32_dpp v12, v44, v26 quad_perm:[0,0,0,0] row_mask:0xf bank_mask:0xf
  v_and_b32_dpp v13, v44, v27 quad_perm:[0,0,0,0] row_mask:0xf bank_mask:0xf
  s_cbranch_vccnz L_sk180
  s_waitcnt vmcnt(4)
L_sk180:
  s_waitcnt vmcnt(5)
  s_add_u32 s7, s7, 32768
  buffer_load_dwordx4 v[208:211], v2, s[44:47], s7 offen offset:0 nt
  s_cbranch_vccnz L_sk181
  s_waitcnt vmcnt(4)
L_sk181:
  s_waitcnt vmcnt(5)
  buffer_load_dwordx4 v[212:215], v2, s[44:47], s7 offen offset:256 nt
  ds_read_b32 v31, v3 offset:9996
  v_mfma_f32_16x16x16_bf16 v[4:7], v[18:19], v[188:189], v[4:7]
  v_mfma_f32_16x16x16_bf16 v[8:11], v[18:19], v[190:191], v[8:11]
  v_and_b32_dpp v14, v45, v26 quad_perm:[0,0,0,0] row_mask:0xf bank_mask:0xf
  v_and_b32_dpp v15, v45, v27 quad_perm:[0,0,0,0] row_mask:0xf bank_mask:0xf
  s_cbranch_vccnz L_sk182
  s_waitcnt vmcnt(4)
L_sk182:
  s_waitcnt vmcnt(5) lgkmcnt(0)
  buffer_load_dwordx4 v[216:219], v2, s[44:47], s7 offen offset:512 nt
  v_cmp_ne_u32 vcc, 0, v31
  v_mfma_f32_16x16x16_bf16 v[4:7], v[12:13], v[192:193], v[4:7]
  v_mfma_f32_16x16x16_bf16 v[8:11], v[12:13], v[194:195], v[8:11]
  v_and_b32_dpp v16, v46, v26 quad_perm:[0,0,0,0] row_mask:0xf bank_mask:0xf
  v_and_b32_dpp v17, v46, v27 quad_perm:[0,0,0,0] row_mask:0xf bank_mask:0xf
  s_waitcnt vmcnt(4)
  buffer_load_dwordx4 v[220:223], v2, s[44:47], s7 offen offset:768 nt
  v_mfma_f32_16x16x16_bf16 v[4:7], v[14:15], v[196:197], v[4:7]
  v_mfma_f32_16x16x16_bf16 v[8:11], v[14:15], v[198:199], v[8:11]
  v_and_b32_dpp v18, v47, v26 quad_perm:[0,0,0,0] row_mask:0xf bank_mask:0xf
  v_and_b32_dpp v19, v47, v27 quad_perm:[0,0,0,0] row_mask:0xf bank_mask:0xf
  v_mfma_f32_16x16x16_bf16 v[4:7], v[16:17], v[200:201], v[4:7]
  v_mfma_f32_16x16x16_bf16 v[8:11], v[16:17], v[202:203], v[8:11]
  v_and_b32_dpp v12, v44, v26 quad_perm:[1,1,1,1] row_mask:0xf bank_mask:0xf
  v_and_b32_dpp v13, v44, v27 quad_perm:[1,1,1,1] row_mask:0xf bank_mask:0xf
  s_cbranch_vccnz L_sk184
  s_waitcnt vmcnt(4)
L_sk184:
  s_waitcnt vmcnt(5)
  s_add_u32 s7, s7, 32768
  buffer_load_dwordx4 v[224:227], v2, s[44:47], s7 offen offset:0 nt
  s_cbranch_vccnz L_sk185
  s_waitcnt vmcnt(4)
L_sk185:
  s_waitcnt vmcnt(5)
  buffer_load_dwordx4 v[228:231], v2, s[44:47], s7 offen offset:256 nt
  ds_read_b32 v31, v3 offset:9996
  v_mfma_f32_16x16x16_bf16 v[4:7], v[18:19], v[204:205], v[4:7]
  v_mfma_f32_16x16x16_bf16 v[8:11], v[18:19], v[206:207], v[8:11]
  v_and_b32_dpp v14, v45, v26 quad_perm:[1,1,1,1] row_mask:0xf bank_mask:0xf
  v_and_b32_dpp v15, v45, v27 quad_perm:[1,1,1,1] row_mask:0xf bank_mask:0xf
  s_cbranch_vccnz L_sk186
  s_waitcnt vmcnt(4)
L_sk186:
  s_waitcnt vmcnt(5) lgkmcnt(0)
  buffer_load_dwordx4 v[232:235], v2, s[44:47], s7 offen offset:512 nt
  v_cmp_ne_u32 vcc, 0, v31
  v_mfma_f32_16x16x16_bf16 v[4:7], v[12:13], v[208:209], v[4:7]
  v_mfma_f32_16x16x16_bf16 v[8:11], v[12:13], v[210:211], v[8:11]
  v_and_b32_dpp v16, v46, v26 quad_perm:[1,1,1,1] row_mask:0xf bank_mask:0xf
  v_and_b32_dpp v17, v46, v27 quad_perm:[1,1,1,1] row_mask:0xf bank_mask:0xf
  s_waitcnt vmcnt(4)
  buffer_load_dwordx4 v[236:239], v2, s[44:47], s7 offen offset:768 nt
  v_mfma_f32_16x16x16_bf16 v[4:7], v[14:15], v[212:213], v[4:7]
  v_mfma_f32_16x16x16_bf16 v[8:11], v[14:15], v[214:215], v[8:11]
  v_and_b32_dpp v18, v47, v26 quad_perm:[1,1,1,1] row_mask:0xf bank_mask:0xf
  v_and_b32_dpp v19, v47, v27 quad_perm:[1,1,1,1] row_mask:0xf bank_mask:0xf
  v_mfma_f32_16x16x16_bf16 v[4:7], v[16:17], v[216:217], v[4:7]
  v_mfma_f32_16x16x16_bf16 v[8:11], v[16:17], v[218:219], v[8:11]
  v_and_b32_dpp v12, v44, v26 quad_perm:[2,2,2,2] row_mask:0xf bank_mask:0xf
  v_and_b32_dpp v13, v44, v27 quad_perm:[2,2,2,2] row_mask:0xf bank_mask:0xf
  s_cbranch_vccnz L_sk188
  s_waitcnt vmcnt(4)
L_sk188:
  s_waitcnt vmcnt(5)
  s_add_u32 s7, s7, 32768
  buffer_load_dwordx4 v[240:243], v2, s[44:47], s7 offen offset:0 nt
  s_cbranch_vccnz L_sk189
  s_waitcnt vmcnt(4)
L_sk189:
  s_waitcnt vmcnt(5)
  buffer_load_dwordx4 v[244:247], v2, s[44:47], s7 offen offset:256 nt
  ds_read_b32 v31, v3 offset:9996
  v_mfma_f32_16x16x16_bf16 v[4:7], v[18:19], v[220:221], v[4:7]
  v_mfma_f32_16x16x16_bf16 v[8:11], v[18:19], v[222:223], v[8:11]
  v_and_b32_dpp v14, v45, v26 quad_perm:[2,2,2,2] row_mask:0xf bank_mask:0xf
  v_and_b32_dpp v15, v45, v27 quad_perm:[2,2,2,2] row_mask:0xf bank_mask:0xf
  s_cbranch_vccnz L_sk190
  s_waitcnt vmcnt(4)
L_sk190:
  s_waitcnt vmcnt(5) lgkmcnt(0)
  buffer_load_dwordx4 v[248:251], v2, s[44:47], s7 offen offset:512 nt
  v_cmp_ne_u32 vcc, 0, v31
  v_mfma_f32_16x16x16_bf16 v[4:7], v[12:13], v[224:225], v[4:7]
  v_mfma_f32_16x16x16_bf16 v[8:11], v[12:13], v[226:227], v[8:11]
  v_fma_f32 v48, v48, s9, v24
  v_fma_f32 v49, v49, s9, v24
  v_fma_f32 v50, v50, s9, v24
  v_fma_f32 v51, v51, s9, v24
  v_exp_f32 v48, v48
  v_exp_f32 v49, v49
  v_exp_f32 v50, v50
  v_exp_f32 v51, v51
  v_add_f32 v20, v48, v49
  v_add_f32 v21, v50, v51
  v_cvt_pk_bf16_f32 v48, v48, v48
  v_cvt_pk_bf16_f32 v49, v49, v49
  v_cvt_pk_bf16_f32 v50, v50, v50
  v_cvt_pk_bf16_f32 v51, v51, v51
  v_add_f32 v20, v20, v21
  v_add_f32 v25, v25, v20
  v_and_b32_dpp v16, v46, v26 quad_perm:[2,2,2,2] row_mask:0xf bank_mask:0xf
  v_and_b32_dpp v17, v46, v27 quad_perm:[2,2,2,2] row_mask:0xf bank_mask:0xf
  s_waitcnt vmcnt(4)
  buffer_load_dwordx4 v[252:255], v2, s[44:47], s7 offen offset:768 nt
  v_mfma_f32_16x16x16_bf16 v[4:7], v[14:15], v[228:229], v[4:7]
  v_mfma_f32_16x16x16_bf16 v[8:11], v[14:15], v[230:231], v[8:11]
  v_and_b32_dpp v18, v47, v26 quad_perm:[2,2,2,2] row_mask:0xf bank_mask:0xf
  v_and_b32_dpp v19, v47, v27 quad_perm:[2,2,2,2] row_mask:0xf bank_mask:0xf
  v_mfma_f32_16x16x16_bf16 v[4:7], v[16:17], v[232:233], v[4:7]
  v_mfma_f32_16x16x16_bf16 v[8:11], v[16:17], v[234:235], v[8:11]
  v_and_b32_dpp v12, v44, v26 quad_perm:[3,3,3,3] row_mask:0xf bank_mask:0xf
  v_and_b32_dpp v13, v44, v27 quad_perm:[3,3,3,3] row_mask:0xf bank_mask:0xf
  s_cbranch_vccnz L_sk192
  s_waitcnt vmcnt(4)
L_sk192:
  s_waitcnt vmcnt(5)
  s_add_u32 s7, s7, 32768
  buffer_load_dwordx4 v[64:67], v2, s[44:47], s7 offen offset:0 nt
  s_cbranch_vccnz L_sk193
  s_waitcnt vmcnt(4)
L_sk193:
  s_waitcnt vmcnt(5)
  buffer_load_dwordx4 v[68:71], v2, s[44:47], s7 offen offset:256 nt
  ds_read_b32 v31, v3 offset:9996
  v_mfma_f32_16x16x16_bf16 v[4:7], v[18:19], v[236:237], v[4:7]
  v_mfma_f32_16x16x16_bf16 v[8:11], v[18:19], v[238:239], v[8:11]
  v_and_b32_dpp v14, v45, v26 quad_perm:[3,3,3,3] row_mask:0xf bank_mask:0xf
  v_and_b32_dpp v15, v45, v27 quad_perm:[3,3,3,3] row_mask:0xf bank_mask:0xf
  s_cbranch_vccnz L_sk194
  s_waitcnt vmcnt(4)
L_sk194:
  s_waitcnt vmcnt(5) lgkmcnt(0)
  buffer_load_dwordx4 v[72:75], v2, s[44:47], s7 offen offset:512 nt
  v_cmp_ne_u32 vcc, 0, v31
  v_mfma_f32_16x16x16_bf16 v[4:7], v[12:13], v[240:241], v[4:7]
  v_mfma_f32_16x16x16_bf16 v[8:11], v[12:13], v[242:243], v[8:11]
  v_and_b32_dpp v16, v46, v26 quad_perm:[3,3,3,3] row_mask:0xf bank_mask:0xf
  v_and_b32_dpp v17, v46, v27 quad_perm:[3,3,3,3] row_mask:0xf bank_mask:0xf
  s_waitcnt vmcnt(4)
  buffer_load_dwordx4 v[76:79], v2, s[44:47], s7 offen offset:768 nt
  v_mfma_f32_16x16x16_bf16 v[4:7], v[14:15], v[244:245], v[4:7]
  v_mfma_f32_16x16x16_bf16 v[8:11], v[14:15], v[246:247], v[8:11]
  v_and_b32_dpp v18, v47, v26 quad_perm:[3,3,3,3] row_mask:0xf bank_mask:0xf
  v_and_b32_dpp v19, v47, v27 quad_perm:[3,3,3,3] row_mask:0xf bank_mask:0xf
  v_mfma_f32_16x16x16_bf16 v[4:7], v[16:17], v[248:249], v[4:7]
  v_mfma_f32_16x16x16_bf16 v[8:11], v[16:17], v[250:251], v[8:11]
  v_and_b32_dpp v12, v48, v26 quad_perm:[0,0,0,0] row_mask:0xf bank_mask:0xf
  v_and_b32_dpp v13, v48, v27 quad_perm:[0,0,0,0] row_mask:0xf bank_mask:0xf
  s_cbranch_vccnz L_sk196
  s_waitcnt vmcnt(4)
L_sk196:
  s_waitcnt vmcnt(5)
  s_add_u32 s7, s7, 32768
  buffer_load_dwordx4 v[80:83], v2, s[44:47], s7 offen offset:0 nt
  s_cbranch_vccnz L_sk197
  s_waitcnt vmcnt(4)
L_sk197:
  s_waitcnt vmcnt(5)
  buffer_load_dwordx4 v[84:87], v2, s[44:47], s7 offen offset:256 nt
  ds_read_b32 v31, v3 offset:9996
  v_mfma_f32_16x16x16_bf16 v[4:7], v[18:19], v[252:253], v[4:7]
  v_mfma_f32_16x16x16_bf16 v[8:11], v[18:19], v[254:255], v[8:11]
  v_and_b32_dpp v14, v49, v26 quad_perm:[0,0,0,0] row_mask:0xf bank_mask:0xf
  v_and_b32_dpp v15, v49, v27 quad_perm:[0,0,0,0] row_mask:0xf bank_mask:0xf
  s_cbranch_vccnz L_sk198
  s_waitcnt vmcnt(4)
L_sk198:
  s_waitcnt vmcnt(5) lgkmcnt(0)
  buffer_load_dwordx4 v[88:91], v2, s[44:47], s7 offen offset:512 nt
  v_cmp_ne_u32 vcc, 0, v31
  v_mfma_f32_16x16x16_bf16 v[4:7], v[12:13], v[64:65], v[4:7]
  v_mfma_f32_16x16x16_bf16 v[8:11], v[12:13], v[66:67], v[8:11]
  v_and_b32_dpp v16, v50, v26 quad_perm:[0,0,0,0] row_mask:0xf bank_mask:0xf
  v_and_b32_dpp v17, v50, v27 quad_perm:[0,0,0,0] row_mask:0xf bank_mask:0xf
  s_waitcnt vmcnt(4)
  buffer_load_dwordx4 v[92:95], v2, s[44:47], s7 offen offset:768 nt
  v_mfma_f32_16x16x16_bf16 v[4:7], v[14:15], v[68:69], v[4:7]
  v_mfma_f32_16x16x16_bf16 v[8:11], v[14:15], v[70:71], v[8:11]
  v_and_b32_dpp v18, v51, v26 quad_perm:[0,0,0,0] row_mask:0xf bank_mask:0xf
  v_and_b32_dpp v19, v51, v27 quad_perm:[0,0,0,0] row_mask:0xf bank_mask:0xf
  v_mfma_f32_16x16x16_bf16 v[4:7], v[16:17], v[72:73], v[4:7]
  v_mfma_f32_16x16x16_bf16 v[8:11], v[16:17], v[74:75], v[8:11]
  v_and_b32_dpp v12, v48, v26 quad_perm:[1,1,1,1] row_mask:0xf bank_mask:0xf
  v_and_b32_dpp v13, v48, v27 quad_perm:[1,1,1,1] row_mask:0xf bank_mask:0xf
  s_cbranch_vccnz L_sk200
  s_waitcnt vmcnt(4)
L_sk200:
  s_waitcnt vmcnt(5)
  s_add_u32 s7, s7, 32768
  buffer_load_dwordx4 v[96:99], v2, s[44:47], s7 offen offset:0 nt
  s_cbranch_vccnz L_sk201
  s_waitcnt vmcnt(4)
L_sk201:
  s_waitcnt vmcnt(5)
  buffer_load_dwordx4 v[100:103], v2, s[44:47], s7 offen offset:256 nt
  ds_read_b32 v31, v3 offset:9996
  v_mfma_f32_16x16x16_bf16 v[4:7], v[18:19], v[76:77], v[4:7]
  v_mfma_f32_16x16x16_bf16 v[8:11], v[18:19], v[78:79], v[8:11]
  v_and_b32_dpp v14, v49, v26 quad_perm:[1,1,1,1] row_mask:0xf bank_mask:0xf
  v_and_b32_dpp v15, v49, v27 quad_perm:[1,1,1,1] row_mask:0xf bank_mask:0xf
  s_cbranch_vccnz L_sk202
  s_waitcnt vmcnt(4)
L_sk202:
  s_waitcnt vmcnt(5) lgkmcnt(0)
  buffer_load_dwordx4 v[104:107], v2, s[44:47], s7 offen offset:512 nt
  v_cmp_ne_u32 vcc, 0, v31
  v_mfma_f32_16x16x16_bf16 v[4:7], v[12:13], v[80:81], v[4:7]
  v_mfma_f32_16x16x16_bf16 v[8:11], v[12:13], v[82:83], v[8:11]
  v_and_b32_dpp v16, v50, v26 quad_perm:[1,1,1,1] row_mask:0xf bank_mask:0xf
  v_and_b32_dpp v17, v50, v27 quad_perm:[1,1,1,1] row_mask:0xf bank_mask:0xf
  s_waitcnt vmcnt(4)
  buffer_load_dwordx4 v[108:111], v2, s[44:47], s7 offen offset:768 nt
  v_mfma_f32_16x16x16_bf16 v[4:7], v[14:15], v[84:85], v[4:7]
  v_mfma_f32_16x16x16_bf16 v[8:11], v[14:15], v[86:87], v[8:11]
  v_and_b32_dpp v18, v51, v26 quad_perm:[1,1,1,1] row_mask:0xf bank_mask:0xf
  v_and_b32_dpp v19, v51, v27 quad_perm:[1,1,1,1] row_mask:0xf bank_mask:0xf
  v_mfma_f32_16x16x16_bf16 v[4:7], v[16:17], v[88:89], v[4:7]
  v_mfma_f32_16x16x16_bf16 v[8:11], v[16:17], v[90:91], v[8:11]
  v_and_b32_dpp v12, v48, v26 quad_perm:[2,2,2,2] row_mask:0xf bank_mask:0xf
  v_and_b32_dpp v13, v48, v27 quad_perm:[2,2,2,2] row_mask:0xf bank_mask:0xf
  s_cbranch_vccnz L_sk204
  s_waitcnt vmcnt(4)
L_sk204:
  s_waitcnt vmcnt(5)
  s_add_u32 s7, s7, 32768
  buffer_load_dwordx4 v[112:115], v2, s[44:47], s7 offen offset:0 nt
  s_cbranch_vccnz L_sk205
  s_waitcnt vmcnt(4)
L_sk205:
  s_waitcnt vmcnt(5)
  buffer_load_dwordx4 v[116:119], v2, s[44:47], s7 offen offset:256 nt
  ds_read_b32 v31, v3 offset:9996
  v_mfma_f32_16x16x16_bf16 v[4:7], v[18:19], v[92:93], v[4:7]
  v_mfma_f32_16x16x16_bf16 v[8:11], v[18:19], v[94:95], v[8:11]
  v_and_b32_dpp v14, v49, v26 quad_perm:[2,2,2,2] row_mask:0xf bank_mask:0xf
  v_and_b32_dpp v15, v49, v27 quad_perm:[2,2,2,2] row_mask:0xf bank_mask:0xf
  s_cbranch_vccnz L_sk206
  s_waitcnt vmcnt(4)
L_sk206:
  s_waitcnt vmcnt(5) lgkmcnt(0)
  buffer_load_dwordx4 v[120:123], v2, s[44:47], s7 offen offset:512 nt
  v_cmp_ne_u32 vcc, 0, v31
  v_mfma_f32_16x16x16_bf16 v[4:7], v[12:13], v[96:97], v[4:7]
  v_mfma_f32_16x16x16_bf16 v[8:11], v[12:13], v[98:99], v[8:11]
  v_fma_f32 v52, v52, s9, v24
  v_fma_f32 v53, v53, s9, v24
  v_fma_f32 v54, v54, s9, v24
  v_fma_f32 v55, v55, s9, v24
  v_exp_f32 v52, v52
  v_exp_f32 v53, v53
  v_exp_f32 v54, v54
  v_exp_f32 v55, v55
  v_add_f32 v20, v52, v53
  v_add_f32 v21, v54, v55
  v_cvt_pk_bf16_f32 v52, v52, v52
  v_cvt_pk_bf16_f32 v53, v53, v53
  v_cvt_pk_bf16_f32 v54, v54, v54
  v_cvt_pk_bf16_f32 v55, v55, v55
  v_add_f32 v20, v20, v21
  v_add_f32 v25, v25, v20
  v_and_b32_dpp v16, v50, v26 quad_perm:[2,2,2,2] row_mask:0xf bank_mask:0xf
  v_and_b32_dpp v17, v50, v27 quad_perm:[2,2,2,2] row_mask:0xf bank_mask:0xf
  s_waitcnt vmcnt(4)
  buffer_load_dwordx4 v[124:127], v2, s[44:47], s7 offen offset:768 nt
  v_mfma_f32_16x16x16_bf16 v[4:7], v[14:15], v[100:101], v[4:7]
  v_mfma_f32_16x16x16_bf16 v[8:11], v[14:15], v[102:103], v[8:11]
  v_and_b32_dpp v18, v51, v26 quad_perm:[2,2,2,2] row_mask:0xf bank_mask:0xf
  v_and_b32_dpp v19, v51, v27 quad_perm:[2,2,2,2] row_mask:0xf bank_mask:0xf
  v_mfma_f32_16x16x16_bf16 v[4:7], v[16:17], v[104:105], v[4:7]
  v_mfma_f32_16x16x16_bf16 v[8:11], v[16:17], v[106:107], v[8:11]
  v_and_b32_dpp v12, v48, v26 quad_perm:[3,3,3,3] row_mask:0xf bank_mask:0xf
  v_and_b32_dpp v13, v48, v27 quad_perm:[3,3,3,3] row_mask:0xf bank_mask:0xf
  s_cbranch_vccnz L_sk208
  s_waitcnt vmcnt(4)
L_sk208:
  s_waitcnt vmcnt(5)
  s_add_u32 s7, s7, 32768
  buffer_load_dwordx4 v[128:131], v2, s[44:47], s7 offen offset:0 nt
  ds_add_u32 v3, v30 offset:10000
  s_cbranch_vccnz L_sk209
  s_waitcnt vmcnt(4)
L_sk209:
  s_waitcnt vmcnt(5)
  buffer_load_dwordx4 v[132:135], v2, s[44:47], s7 offen offset:256 nt
  ds_read_b32 v31, v3 offset:9996
  v_mfma_f32_16x16x16_bf16 v[4:7], v[18:19], v[108:109], v[4:7]
  v_mfma_f32_16x16x16_bf16 v[8:11], v[18:19], v[110:111], v[8:11]
  v_and_b32_dpp v14, v49, v26 quad_perm:[3,3,3,3] row_mask:0xf bank_mask:0xf
  v_and_b32_dpp v15, v49, v27 quad_perm:[3,3,3,3] row_mask:0xf bank_mask:0xf
  s_cbranch_vccnz L_sk210
  s_waitcnt vmcnt(4)
L_sk210:
  s_waitcnt vmcnt(5) lgkmcnt(0)
  buffer_load_dwordx4 v[136:139], v2, s[44:47], s7 offen offset:512 nt
  v_cmp_ne_u32 vcc, 0, v31
  v_mfma_f32_16x16x16_bf16 v[4:7], v[12:13], v[112:113], v[4:7]
  v_mfma_f32_16x16x16_bf16 v[8:11], v[12:13], v[114:115], v[8:11]
  v_and_b32_dpp v16, v50, v26 quad_perm:[3,3,3,3] row_mask:0xf bank_mask:0xf
  v_and_b32_dpp v17, v50, v27 quad_perm:[3,3,3,3] row_mask:0xf bank_mask:0xf
  s_waitcnt vmcnt(4)
  buffer_load_dwordx4 v[140:143], v2, s[44:47], s7 offen offset:768 nt
  v_mfma_f32_16x16x16_bf16 v[4:7], v[14:15], v[116:117], v[4:7]
  v_mfma_f32_16x16x16_bf16 v[8:11], v[14:15], v[118:119], v[8:11]
  v_and_b32_dpp v18, v51, v26 quad_perm:[3,3,3,3] row_mask:0xf bank_mask:0xf
  v_and_b32_dpp v19, v51, v27 quad_perm:[3,3,3,3] row_mask:0xf bank_mask:0xf
  v_mfma_f32_16x16x16_bf16 v[4:7], v[16:17], v[120:121], v[4:7]
  v_mfma_f32_16x16x16_bf16 v[8:11], v[16:17], v[122:123], v[8:11]
  v_and_b32_dpp v12, v52, v26 quad_perm:[0,0,0,0] row_mask:0xf bank_mask:0xf
  v_and_b32_dpp v13, v52, v27 quad_perm:[0,0,0,0] row_mask:0xf bank_mask:0xf
  s_cbranch_vccnz L_sk212
  s_waitcnt vmcnt(4)
L_sk212:
  s_waitcnt vmcnt(5)
  s_add_u32 s7, s7, 32768
  buffer_load_dwordx4 v[144:147], v2, s[44:47], s7 offen offset:0 nt
  s_cbranch_vccnz L_sk213
  s_waitcnt vmcnt(4)
L_sk213:
  s_waitcnt vmcnt(5)
  buffer_load_dwordx4 v[148:151], v2, s[44:47], s7 offen offset:256 nt
  ds_read_b32 v31, v3 offset:9996
  v_mfma_f32_16x16x16_bf16 v[4:7], v[18:19], v[124:125], v[4:7]
  v_mfma_f32_16x16x16_bf16 v[8:11], v[18:19], v[126:127], v[8:11]
  v_and_b32_dpp v14, v53, v26 quad_perm:[0,0,0,0] row_mask:0xf bank_mask:0xf
  v_and_b32_dpp v15, v53, v27 quad_perm:[0,0,0,0] row_mask:0xf bank_mask:0xf
  s_cbranch_vccnz L_sk214
  s_waitcnt vmcnt(4)
L_sk214:
  s_waitcnt vmcnt(5) lgkmcnt(0)
  buffer_load_dwordx4 v[152:155], v2, s[44:47], s7 offen offset:512 nt
  v_cmp_ne_u32 vcc, 0, v31
  v_mfma_f32_16x16x16_bf16 v[4:7], v[12:13], v[128:129], v[4:7]
  v_mfma_f32_16x16x16_bf16 v[8:11], v[12:13], v[130:131], v[8:11]
  v_and_b32_dpp v16, v54, v26 quad_perm:[0,0,0,0] row_mask:0xf bank_mask:0xf
  v_and_b32_dpp v17, v54, v27 quad_perm:[0,0,0,0] row_mask:0xf bank_mask:0xf
  s_waitcnt vmcnt(4)
  buffer_load_dwordx4 v[156:159], v2, s[44:47], s7 offen offset:768 nt
  v_mfma_f32_16x16x16_bf16 v[4:7], v[14:15], v[132:133], v[4:7]
  v_mfma_f32_16x16x16_bf16 v[8:11], v[14:15], v[134:135], v[8:11]
  v_and_b32_dpp v18, v55, v26 quad_perm:[0,0,0,0] row_mask:0xf bank_mask:0xf
  v_and_b32_dpp v19, v55, v27 quad_perm:[0,0,0,0] row_mask:0xf bank_mask:0xf
  v_mfma_f32_16x16x16_bf16 v[4:7], v[16:17], v[136:137], v[4:7]
  v_mfma_f32_16x16x16_bf16 v[8:11], v[16:17], v[138:139], v[8:11]
  v_and_b32_dpp v12, v52, v26 quad_perm:[1,1,1,1] row_mask:0xf bank_mask:0xf
  v_and_b32_dpp v13, v52, v27 quad_perm:[1,1,1,1] row_mask:0xf bank_mask:0xf
  s_cbranch_vccnz L_sk216
  s_waitcnt vmcnt(4)
L_sk216:
  s_waitcnt vmcnt(5)
  s_add_u32 s7, s7, 32768
  buffer_load_dwordx4 v[160:163], v2, s[44:47], s7 offen offset:0 nt
  s_cbranch_vccnz L_sk217
  s_waitcnt vmcnt(4)
L_sk217:
  s_waitcnt vmcnt(5)
  buffer_load_dwordx4 v[164:167], v2, s[44:47], s7 offen offset:256 nt
  ds_read_b32 v31, v3 offset:9996
  v_mfma_f32_16x16x16_bf16 v[4:7], v[18:19], v[140:141], v[4:7]
  v_mfma_f32_16x16x16_bf16 v[8:11], v[18:19], v[142:143], v[8:11]
  v_and_b32_dpp v14, v53, v26 quad_perm:[1,1,1,1] row_mask:0xf bank_mask:0xf
  v_and_b32_dpp v15, v53, v27 quad_perm:[1,1,1,1] row_mask:0xf bank_mask:0xf
  s_cbranch_vccnz L_sk218
  s_waitcnt vmcnt(4)
L_sk218:
  s_waitcnt vmcnt(5) lgkmcnt(0)
  buffer_load_dwordx4 v[168:171], v2, s[44:47], s7 offen offset:512 nt
  v_cmp_ne_u32 vcc, 0, v31
  v_mfma_f32_16x16x16_bf16 v[4:7], v[12:13], v[144:145], v[4:7]
  v_mfma_f32_16x16x16_bf16 v[8:11], v[12:13], v[146:147], v[8:11]
  v_and_b32_dpp v16, v54, v26 quad_perm:[1,1,1,1] row_mask:0xf bank_mask:0xf
  v_and_b32_dpp v17, v54, v27 quad_perm:[1,1,1,1] row_mask:0xf bank_mask:0xf
  s_waitcnt vmcnt(4)
  buffer_load_dwordx4 v[172:175], v2, s[44:47], s7 offen offset:768 nt
  v_mfma_f32_16x16x16_bf16 v[4:7], v[14:15], v[148:149], v[4:7]
  v_mfma_f32_16x16x16_bf16 v[8:11], v[14:15], v[150:151], v[8:11]
  v_and_b32_dpp v18, v55, v26 quad_perm:[1,1,1,1] row_mask:0xf bank_mask:0xf
  v_and_b32_dpp v19, v55, v27 quad_perm:[1,1,1,1] row_mask:0xf bank_mask:0xf
  v_mfma_f32_16x16x16_bf16 v[4:7], v[16:17], v[152:153], v[4:7]
  v_mfma_f32_16x16x16_bf16 v[8:11], v[16:17], v[154:155], v[8:11]
  v_and_b32_dpp v12, v52, v26 quad_perm:[2,2,2,2] row_mask:0xf bank_mask:0xf
  v_and_b32_dpp v13, v52, v27 quad_perm:[2,2,2,2] row_mask:0xf bank_mask:0xf
  s_cbranch_vccnz L_sk220
  s_waitcnt vmcnt(4)
L_sk220:
  s_waitcnt vmcnt(5)
  s_add_u32 s7, s7, 32768
  buffer_load_dwordx4 v[176:179], v2, s[44:47], s7 offen offset:0 nt
  s_cbranch_vccnz L_sk221
  s_waitcnt vmcnt(4)
L_sk221:
  s_waitcnt vmcnt(5)
  buffer_load_dwordx4 v[180:183], v2, s[44:47], s7 offen offset:256 nt
  ds_read_b32 v31, v3 offset:9996
  v_mfma_f32_16x16x16_bf16 v[4:7], v[18:19], v[156:157], v[4:7]
  v_mfma_f32_16x16x16_bf16 v[8:11], v[18:19], v[158:159], v[8:11]
  v_and_b32_dpp v14, v53, v26 quad_perm:[2,2,2,2] row_mask:0xf bank_mask:0xf
  v_and_b32_dpp v15, v53, v27 quad_perm:[2,2,2,2] row_mask:0xf bank_mask:0xf
  s_cbranch_vccnz L_sk222
  s_waitcnt vmcnt(4)
L_sk222:
  s_waitcnt vmcnt(5) lgkmcnt(0)
  buffer_load_dwordx4 v[184:187], v2, s[44:47], s7 offen offset:512 nt
  v_cmp_ne_u32 vcc, 0, v31
  v_mfma_f32_16x16x16_bf16 v[4:7], v[12:13], v[160:161], v[4:7]
  v_mfma_f32_16x16x16_bf16 v[8:11], v[12:13], v[162:163], v[8:11]
  v_fma_f32 v56, v56, s9, v24
  v_fma_f32 v57, v57, s9, v24
  v_fma_f32 v58, v58, s9, v24
  v_fma_f32 v59, v59, s9, v24
  v_exp_f32 v56, v56
  v_exp_f32 v57, v57
  v_exp_f32 v58, v58
  v_exp_f32 v59, v59
  v_add_f32 v20, v56, v57
  v_add_f32 v21, v58, v59
  v_cvt_pk_bf16_f32 v56, v56, v56
  v_cvt_pk_bf16_f32 v57, v57, v57
  v_cvt_pk_bf16_f32 v58, v58, v58
  v_cvt_pk_bf16_f32 v59, v59, v59
  v_add_f32 v20, v20, v21
  v_add_f32 v25, v25, v20
  v_and_b32_dpp v16, v54, v26 quad_perm:[2,2,2,2] row_mask:0xf bank_mask:0xf
  v_and_b32_dpp v17, v54, v27 quad_perm:[2,2,2,2] row_mask:0xf bank_mask:0xf
  s_waitcnt vmcnt(4)
  buffer_load_dwordx4 v[188:191], v2, s[44:47], s7 offen offset:768 nt
  v_mfma_f32_16x16x16_bf16 v[4:7], v[14:15], v[164:165], v[4:7]
  v_mfma_f32_16x16x16_bf16 v[8:11], v[14:15], v[166:167], v[8:11]
  v_and_b32_dpp v18, v55, v26 quad_perm:[2,2,2,2] row_mask:0xf bank_mask:0xf
  v_and_b32_dpp v19, v55, v27 quad_perm:[2,2,2,2] row_mask:0xf bank_mask:0xf
  v_mfma_f32_16x16x16_bf16 v[4:7], v[16:17], v[168:169], v[4:7]
  v_mfma_f32_16x16x16_bf16 v[8:11], v[16:17], v[170:171], v[8:11]
  v_and_b32_dpp v12, v52, v26 quad_perm:[3,3,3,3] row_mask:0xf bank_mask:0xf
  v_and_b32_dpp v13, v52, v27 quad_perm:[3,3,3,3] row_mask:0xf bank_mask:0xf
  s_cbranch_vccnz L_sk224
  s_waitcnt vmcnt(4)
L_sk224:
  s_waitcnt vmcnt(5)
  s_add_u32 s7, s7, 32768
  buffer_load_dwordx4 v[192:195], v2, s[44:47], s7 offen offset:0 nt
  s_cbranch_vccnz L_sk225
  s_waitcnt vmcnt(4)
L_sk225:
  s_waitcnt vmcnt(5)
  buffer_load_dwordx4 v[196:199], v2, s[44:47], s7 offen offset:256 nt
  ds_read_b32 v31, v3 offset:9996
  v_mfma_f32_16x16x16_bf16 v[4:7], v[18:19], v[172:173], v[4:7]
  v_mfma_f32_16x16x16_bf16 v[8:11], v[18:19], v[174:175], v[8:11]
  v_and_b32_dpp v14, v53, v26 quad_perm:[3,3,3,3] row_mask:0xf bank_mask:0xf
  v_and_b32_dpp v15, v53, v27 quad_perm:[3,3,3,3] row_mask:0xf bank_mask:0xf
  s_cbranch_vccnz L_sk226
  s_waitcnt vmcnt(4)
L_sk226:
  s_waitcnt vmcnt(5) lgkmcnt(0)
  buffer_load_dwordx4 v[200:203], v2, s[44:47], s7 offen offset:512 nt
  v_cmp_ne_u32 vcc, 0, v31
  v_mfma_f32_16x16x16_bf16 v[4:7], v[12:13], v[176:177], v[4:7]
  v_mfma_f32_16x16x16_bf16 v[8:11], v[12:13], v[178:179], v[8:11]
  v_and_b32_dpp v16, v54, v26 quad_perm:[3,3,3,3] row_mask:0xf bank_mask:0xf
  v_and_b32_dpp v17, v54, v27 quad_perm:[3,3,3,3] row_mask:0xf bank_mask:0xf
  s_waitcnt vmcnt(4)
  buffer_load_dwordx4 v[204:207], v2, s[44:47], s7 offen offset:768 nt
  v_mfma_f32_16x16x16_bf16 v[4:7], v[14:15], v[180:181], v[4:7]
  v_mfma_f32_16x16x16_bf16 v[8:11], v[14:15], v[182:183], v[8:11]
  v_and_b32_dpp v18, v55, v26 quad_perm:[3,3,3,3] row_mask:0xf bank_mask:0xf
  v_and_b32_dpp v19, v55, v27 quad_perm:[3,3,3,3] row_mask:0xf bank_mask:0xf
  v_mfma_f32_16x16x16_bf16 v[4:7], v[16:17], v[184:185], v[4:7]
  v_mfma_f32_16x16x16_bf16 v[8:11], v[16:17], v[186:187], v[8:11]
  v_and_b32_dpp v12, v56, v26 quad_perm:[0,0,0,0] row_mask:0xf bank_mask:0xf
  v_and_b32_dpp v13, v56, v27 quad_perm:[0,0,0,0] row_mask:0xf bank_mask:0xf
  s_cbranch_vccnz L_sk228
  s_waitcnt vmcnt(4)
L_sk228:
  s_waitcnt vmcnt(5)
  s_add_u32 s7, s7, 32768
  buffer_load_dwordx4 v[208:211], v2, s[44:47], s7 offen offset:0 nt
  s_cbranch_vccnz L_sk229
  s_waitcnt vmcnt(4)
L_sk229:
  s_waitcnt vmcnt(5)
  buffer_load_dwordx4 v[212:215], v2, s[44:47], s7 offen offset:256 nt
  ds_read_b32 v31, v3 offset:9996
  v_mfma_f32_16x16x16_bf16 v[4:7], v[18:19], v[188:189], v[4:7]
  v_mfma_f32_16x16x16_bf16 v[8:11], v[18:19], v[190:191], v[8:11]
  v_and_b32_dpp v14, v57, v26 quad_perm:[0,0,0,0] row_mask:0xf bank_mask:0xf
  v_and_b32_dpp v15, v57, v27 quad_perm:[0,0,0,0] row_mask:0xf bank_mask:0xf
  s_cbranch_vccnz L_sk230
  s_waitcnt vmcnt(4)
L_sk230:
  s_waitcnt vmcnt(5) lgkmcnt(0)
  buffer_load_dwordx4 v[216:219], v2, s[44:47], s7 offen offset:512 nt
  v_cmp_ne_u32 vcc, 0, v31
  v_mfma_f32_16x16x16_bf16 v[4:7], v[12:13], v[192:193], v[4:7]
  v_mfma_f32_16x16x16_bf16 v[8:11], v[12:13], v[194:195], v[8:11]
  v_and_b32_dpp v16, v58, v26 quad_perm:[0,0,0,0] row_mask:0xf bank_mask:0xf
  v_and_b32_dpp v17, v58, v27 quad_perm:[0,0,0,0] row_mask:0xf bank_mask:0xf
  s_waitcnt vmcnt(4)
  buffer_load_dwordx4 v[220:223], v2, s[44:47], s7 offen offset:768 nt
  v_mfma_f32_16x16x16_bf16 v[4:7], v[14:15], v[196:197], v[4:7]
  v_mfma_f32_16x16x16_bf16 v[8:11], v[14:15], v[198:199], v[8:11]
  v_and_b32_dpp v18, v59, v26 quad_perm:[0,0,0,0] row_mask:0xf bank_mask:0xf
  v_and_b32_dpp v19, v59, v27 quad_perm:[0,0,0,0] row_mask:0xf bank_mask:0xf
  v_mfma_f32_16x16x16_bf16 v[4:7], v[16:17], v[200:201], v[4:7]
  v_mfma_f32_16x16x16_bf16 v[8:11], v[16:17], v[202:203], v[8:11]
  v_and_b32_dpp v12, v56, v26 quad_perm:[1,1,1,1] row_mask:0xf bank_mask:0xf
  v_and_b32_dpp v13, v56, v27 quad_perm:[1,1,1,1] row_mask:0xf bank_mask:0xf
  s_cbranch_vccnz L_sk232
  s_waitcnt vmcnt(4)
L_sk232:
  s_waitcnt vmcnt(5)
  s_add_u32 s7, s7, 32768
  buffer_load_dwordx4 v[224:227], v2, s[44:47], s7 offen offset:0 nt
  s_cbranch_vccnz L_sk233
  s_waitcnt vmcnt(4)
L_sk233:
  s_waitcnt vmcnt(5)
  buffer_load_dwordx4 v[228:231], v2, s[44:47], s7 offen offset:256 nt
  ds_read_b32 v31, v3 offset:9996
  v_mfma_f32_16x16x16_bf16 v[4:7], v[18:19], v[204:205], v[4:7]
  v_mfma_f32_16x16x16_bf16 v[8:11], v[18:19], v[206:207], v[8:11]
  v_and_b32_dpp v14, v57, v26 quad_perm:[1,1,1,1] row_mask:0xf bank_mask:0xf
  v_and_b32_dpp v15, v57, v27 quad_perm:[1,1,1,1] row_mask:0xf bank_mask:0xf
  s_cbranch_vccnz L_sk234
  s_waitcnt vmcnt(4)
L_sk234:
  s_waitcnt vmcnt(5) lgkmcnt(0)
  buffer_load_dwordx4 v[232:235], v2, s[44:47], s7 offen offset:512 nt
  v_cmp_ne_u32 vcc, 0, v31
  v_mfma_f32_16x16x16_bf16 v[4:7], v[12:13], v[208:209], v[4:7]
  v_mfma_f32_16x16x16_bf16 v[8:11], v[12:13], v[210:211], v[8:11]
  v_and_b32_dpp v16, v58, v26 quad_perm:[1,1,1,1] row_mask:0xf bank_mask:0xf
  v_and_b32_dpp v17, v58, v27 quad_perm:[1,1,1,1] row_mask:0xf bank_mask:0xf
  s_waitcnt vmcnt(4)
  buffer_load_dwordx4 v[236:239], v2, s[44:47], s7 offen offset:768 nt
  v_mfma_f32_16x16x16_bf16 v[4:7], v[14:15], v[212:213], v[4:7]
  v_mfma_f32_16x16x16_bf16 v[8:11], v[14:15], v[214:215], v[8:11]
  v_and_b32_dpp v18, v59, v26 quad_perm:[1,1,1,1] row_mask:0xf bank_mask:0xf
  v_and_b32_dpp v19, v59, v27 quad_perm:[1,1,1,1] row_mask:0xf bank_mask:0xf
  v_mfma_f32_16x16x16_bf16 v[4:7], v[16:17], v[216:217], v[4:7]
  v_mfma_f32_16x16x16_bf16 v[8:11], v[16:17], v[218:219], v[8:11]
  v_and_b32_dpp v12, v56, v26 quad_perm:[2,2,2,2] row_mask:0xf bank_mask:0xf
  v_and_b32_dpp v13, v56, v27 quad_perm:[2,2,2,2] row_mask:0xf bank_mask:0xf
  s_cbranch_vccnz L_sk236
  s_waitcnt vmcnt(4)
L_sk236:
  s_waitcnt vmcnt(5)
  s_add_u32 s7, s7, 32768
  buffer_load_dwordx4 v[240:243], v2, s[44:47], s7 offen offset:0 nt
  s_cbranch_vccnz L_sk237
  s_waitcnt vmcnt(4)
L_sk237:
  s_waitcnt vmcnt(5)
  buffer_load_dwordx4 v[244:247], v2, s[44:47], s7 offen offset:256 nt
  ds_read_b32 v31, v3 offset:9996
  v_mfma_f32_16x16x16_bf16 v[4:7], v[18:19], v[220:221], v[4:7]
  v_mfma_f32_16x16x16_bf16 v[8:11], v[18:19], v[222:223], v[8:11]
  v_and_b32_dpp v14, v57, v26 quad_perm:[2,2,2,2] row_mask:0xf bank_mask:0xf
  v_and_b32_dpp v15, v57, v27 quad_perm:[2,2,2,2] row_mask:0xf bank_mask:0xf
  s_cbranch_vccnz L_sk238
  s_waitcnt vmcnt(4)
L_sk238:
  s_waitcnt vmcnt(5) lgkmcnt(0)
  buffer_load_dwordx4 v[248:251], v2, s[44:47], s7 offen offset:512 nt
  v_cmp_ne_u32 vcc, 0, v31
  v_mfma_f32_16x16x16_bf16 v[4:7], v[12:13], v[224:225], v[4:7]
  v_mfma_f32_16x16x16_bf16 v[8:11], v[12:13], v[226:227], v[8:11]
  v_fma_f32 v60, v60, s9, v24
  v_fma_f32 v61, v61, s9, v24
  v_fma_f32 v62, v62, s9, v24
  v_fma_f32 v63, v63, s9, v24
  v_exp_f32 v60, v60
  v_exp_f32 v61, v61
  v_exp_f32 v62, v62
  v_exp_f32 v63, v63
  v_add_f32 v20, v60, v61
  v_add_f32 v21, v62, v63
  v_cvt_pk_bf16_f32 v60, v60, v60
  v_cvt_pk_bf16_f32 v61, v61, v61
  v_cvt_pk_bf16_f32 v62, v62, v62
  v_cvt_pk_bf16_f32 v63, v63, v63
  v_add_f32 v20, v20, v21
  v_add_f32 v25, v25, v20
  s_nop 1
  v_add_f32_dpp v25, v25, v25 quad_perm:[1,0,3,2] row_mask:0xf bank_mask:0xf
  s_nop 1
  v_add_f32_dpp v25, v25, v25 quad_perm:[2,3,0,1] row_mask:0xf bank_mask:0xf
  v_mov_b32 v29, v25
  s_nop 1
  v_permlane16_swap_b32 v25, v29
  v_add_f32 v25, v25, v29
  v_mov_b32 v29, v25
  s_nop 1
  v_permlane32_swap_b32 v25, v29
  v_add_f32 v25, v25, v29
  v_lshlrev_b32 v22, 3, v0
  s_lshl_b32 s10, s3, 3
  v_add_u32 v22, s10, v22
  s_mov_b64 exec, 0x1111
  ds_write_b64 v22, v[24:25] offset:9216
  s_mov_b64 exec, -1
  v_and_b32_dpp v16, v58, v26 quad_perm:[2,2,2,2] row_mask:0xf bank_mask:0xf
  v_and_b32_dpp v17, v58, v27 quad_perm:[2,2,2,2] row_mask:0xf bank_mask:0xf
  s_waitcnt vmcnt(4)
  buffer_load_dwordx4 v[252:255], v2, s[44:47], s7 offen offset:768 nt
  v_mfma_f32_16x16x16_bf16 v[4:7], v[14:15], v[228:229], v[4:7]
  v_mfma_f32_16x16x16_bf16 v[8:11], v[14:15], v[230:231], v[8:11]
  v_and_b32_dpp v18, v59, v26 quad_perm:[2,2,2,2] row_mask:0xf bank_mask:0xf
  v_and_b32_dpp v19, v59, v27 quad_perm:[2,2,2,2] row_mask:0xf bank_mask:0xf
  v_mfma_f32_16x16x16_bf16 v[4:7], v[16:17], v[232:233], v[4:7]
  v_mfma_f32_16x16x16_bf16 v[8:11], v[16:17], v[234:235], v[8:11]
  v_and_b32_dpp v12, v56, v26 quad_perm:[3,3,3,3] row_mask:0xf bank_mask:0xf
  v_and_b32_dpp v13, v56, v27 quad_perm:[3,3,3,3] row_mask:0xf bank_mask:0xf
  s_cbranch_vccnz L_sk240
  s_waitcnt vmcnt(4)
L_sk240:
  s_waitcnt vmcnt(5)
  s_add_u32 s7, s7, 32768
  buffer_load_dwordx4 v[64:67], v2, s[44:47], s7 offen offset:0 nt
  s_cbranch_vccnz L_sk241
  s_waitcnt vmcnt(4)
L_sk241:
  s_waitcnt vmcnt(5)
  buffer_load_dwordx4 v[68:71], v2, s[44:47], s7 offen offset:256 nt
  ds_read_b32 v31, v3 offset:9996
  v_mfma_f32_16x16x16_bf16 v[4:7], v[18:19], v[236:237], v[4:7]
  v_mfma_f32_16x16x16_bf16 v[8:11], v[18:19], v[238:239], v[8:11]
  v_and_b32_dpp v14, v57, v26 quad_perm:[3,3,3,3] row_mask:0xf bank_mask:0xf
  v_and_b32_dpp v15, v57, v27 quad_perm:[3,3,3,3] row_mask:0xf bank_mask:0xf
  s_cbranch_vccnz L_sk242
  s_waitcnt vmcnt(4)
L_sk242:
  s_waitcnt vmcnt(5) lgkmcnt(0)
  buffer_load_dwordx4 v[72:75], v2, s[44:47], s7 offen offset:512 nt
  v_cmp_ne_u32 vcc, 0, v31
  v_mfma_f32_16x16x16_bf16 v[4:7], v[12:13], v[240:241], v[4:7]
  v_mfma_f32_16x16x16_bf16 v[8:11], v[12:13], v[242:243], v[8:11]
  v_and_b32_dpp v16, v58, v26 quad_perm:[3,3,3,3] row_mask:0xf bank_mask:0xf
  v_and_b32_dpp v17, v58, v27 quad_perm:[3,3,3,3] row_mask:0xf bank_mask:0xf
  s_waitcnt vmcnt(4)
  buffer_load_dwordx4 v[76:79], v2, s[44:47], s7 offen offset:768 nt
  v_mfma_f32_16x16x16_bf16 v[4:7], v[14:15], v[244:245], v[4:7]
  v_mfma_f32_16x16x16_bf16 v[8:11], v[14:15], v[246:247], v[8:11]
  v_and_b32_dpp v18, v59, v26 quad_perm:[3,3,3,3] row_mask:0xf bank_mask:0xf
  v_and_b32_dpp v19, v59, v27 quad_perm:[3,3,3,3] row_mask:0xf bank_mask:0xf
  v_mfma_f32_16x16x16_bf16 v[4:7], v[16:17], v[248:249], v[4:7]
  v_mfma_f32_16x16x16_bf16 v[8:11], v[16:17], v[250:251], v[8:11]
  v_and_b32_dpp v12, v60, v26 quad_perm:[0,0,0,0] row_mask:0xf bank_mask:0xf
  v_and_b32_dpp v13, v60, v27 quad_perm:[0,0,0,0] row_mask:0xf bank_mask:0xf
  s_cbranch_vccnz L_sk244
  s_waitcnt vmcnt(4)
L_sk244:
  s_waitcnt vmcnt(5)
  s_add_u32 s7, s7, 32768
  buffer_load_dwordx4 v[80:83], v2, s[44:47], s7 offen offset:0 nt
  s_cbranch_vccnz L_sk245
  s_waitcnt vmcnt(4)
L_sk245:
  s_waitcnt vmcnt(5)
  buffer_load_dwordx4 v[84:87], v2, s[44:47], s7 offen offset:256 nt
  ds_read_b32 v31, v3 offset:9996
  v_mfma_f32_16x16x16_bf16 v[4:7], v[18:19], v[252:253], v[4:7]
  v_mfma_f32_16x16x16_bf16 v[8:11], v[18:19], v[254:255], v[8:11]
  v_and_b32_dpp v14, v61, v26 quad_perm:[0,0,0,0] row_mask:0xf bank_mask:0xf
  v_and_b32_dpp v15, v61, v27 quad_perm:[0,0,0,0] row_mask:0xf bank_mask:0xf
  s_cbranch_vccnz L_sk246
  s_waitcnt vmcnt(4)
L_sk246:
  s_waitcnt vmcnt(5) lgkmcnt(0)
  buffer_load_dwordx4 v[88:91], v2, s[44:47], s7 offen offset:512 nt
  v_cmp_ne_u32 vcc, 0, v31
  v_mfma_f32_16x16x16_bf16 v[4:7], v[12:13], v[64:65], v[4:7]
  v_mfma_f32_16x16x16_bf16 v[8:11], v[12:13], v[66:67], v[8:11]
  v_and_b32_dpp v16, v62, v26 quad_perm:[0,0,0,0] row_mask:0xf bank_mask:0xf
  v_and_b32_dpp v17, v62, v27 quad_perm:[0,0,0,0] row_mask:0xf bank_mask:0xf
  s_waitcnt vmcnt(4)
  buffer_load_dwordx4 v[92:95], v2, s[44:47], s7 offen offset:768 nt
  v_mfma_f32_16x16x16_bf16 v[4:7], v[14:15], v[68:69], v[4:7]
  v_mfma_f32_16x16x16_bf16 v[8:11], v[14:15], v[70:71], v[8:11]
  v_and_b32_dpp v18, v63, v26 quad_perm:[0,0,0,0] row_mask:0xf bank_mask:0xf
  v_and_b32_dpp v19, v63, v27 quad_perm:[0,0,0,0] row_mask:0xf bank_mask:0xf
  v_mfma_f32_16x16x16_bf16 v[4:7], v[16:17], v[72:73], v[4:7]
  v_mfma_f32_16x16x16_bf16 v[8:11], v[16:17], v[74:75], v[8:11]
  v_and_b32_dpp v12, v60, v26 quad_perm:[1,1,1,1] row_mask:0xf bank_mask:0xf
  v_and_b32_dpp v13, v60, v27 quad_perm:[1,1,1,1] row_mask:0xf bank_mask:0xf
  ds_write_b32 v37, v38 offset:9992
  s_cbranch_vccnz L_sk248
  s_waitcnt vmcnt(4)
L_sk248:
  s_waitcnt vmcnt(5)
  s_add_u32 s7, s7, 32768
  buffer_load_dwordx4 v[96:99], v2, s[44:47], s7 offen offset:0 nt
  s_cbranch_vccnz L_sk249
  s_waitcnt vmcnt(4)
L_sk249:
  s_waitcnt vmcnt(5)
  buffer_load_dwordx4 v[100:103], v2, s[44:47], s7 offen offset:256 nt
  ds_read_b32 v31, v3 offset:9996
  v_mfma_f32_16x16x16_bf16 v[4:7], v[18:19], v[76:77], v[4:7]
  v_mfma_f32_16x16x16_bf16 v[8:11], v[18:19], v[78:79], v[8:11]
  v_and_b32_dpp v14, v61, v26 quad_perm:[1,1,1,1] row_mask:0xf bank_mask:0xf
  v_and_b32_dpp v15, v61, v27 quad_perm:[1,1,1,1] row_mask:0xf bank_mask:0xf
  s_cbranch_vccnz L_sk250
  s_waitcnt vmcnt(4)
L_sk250:
  s_waitcnt vmcnt(5) lgkmcnt(0)
  buffer_load_dwordx4 v[104:107], v2, s[44:47], s7 offen offset:512 nt
  v_cmp_ne_u32 vcc, 0, v31
  v_mfma_f32_16x16x16_bf16 v[4:7], v[12:13], v[80:81], v[4:7]
  v_mfma_f32_16x16x16_bf16 v[8:11], v[12:13], v[82:83], v[8:11]
  v_and_b32_dpp v16, v62, v26 quad_perm:[1,1,1,1] row_mask:0xf bank_mask:0xf
  v_and_b32_dpp v17, v62, v27 quad_perm:[1,1,1,1] row_mask:0xf bank_mask:0xf
  s_waitcnt vmcnt(4)
  buffer_load_dwordx4 v[108:111], v2, s[44:47], s7 offen offset:768 nt
  v_mfma_f32_16x16x16_bf16 v[4:7], v[14:15], v[84:85], v[4:7]
  v_mfma_f32_16x16x16_bf16 v[8:11], v[14:15], v[86:87], v[8:11]
  v_and_b32_dpp v18, v63, v26 quad_perm:[1,1,1,1] row_mask:0xf bank_mask:0xf
  v_and_b32_dpp v19, v63, v27 quad_perm:[1,1,1,1] row_mask:0xf bank_mask:0xf
  v_mfma_f32_16x16x16_bf16 v[4:7], v[16:17], v[88:89], v[4:7]
  v_mfma_f32_16x16x16_bf16 v[8:11], v[16:17], v[90:91], v[8:11]
  v_and_b32_dpp v12, v60, v26 quad_perm:[2,2,2,2] row_mask:0xf bank_mask:0xf
  v_and_b32_dpp v13, v60, v27 quad_perm:[2,2,2,2] row_mask:0xf bank_mask:0xf
  s_cbranch_vccnz L_sk252
  s_waitcnt vmcnt(4)
L_sk252:
  s_waitcnt vmcnt(5)
  s_add_u32 s7, s7, 32768
  buffer_load_dwordx4 v[112:115], v2, s[44:47], s7 offen offset:0 nt
  s_cbranch_vccnz L_sk253
  s_waitcnt vmcnt(4)
L_sk253:
  s_waitcnt vmcnt(5)
  buffer_load_dwordx4 v[116:119], v2, s[44:47], s7 offen offset:256 nt
  ds_read_b32 v31, v3 offset:9996
  v_mfma_f32_16x16x16_bf16 v[4:7], v[18:19], v[92:93], v[4:7]
  v_mfma_f32_16x16x16_bf16 v[8:11], v[18:19], v[94:95], v[8:11]
  v_and_b32_dpp v14, v61, v26 quad_perm:[2,2,2,2] row_mask:0xf bank_mask:0xf
  v_and_b32_dpp v15, v61, v27 quad_perm:[2,2,2,2] row_mask:0xf bank_mask:0xf
  s_cbranch_vccnz L_sk254
  s_waitcnt vmcnt(4)
L_sk254:
  s_waitcnt vmcnt(5) lgkmcnt(0)
  buffer_load_dwordx4 v[120:123], v2, s[44:47], s7 offen offset:512 nt
  v_cmp_ne_u32 vcc, 0, v31
  v_mfma_f32_16x16x16_bf16 v[4:7], v[12:13], v[96:97], v[4:7]
  v_mfma_f32_16x16x16_bf16 v[8:11], v[12:13], v[98:99], v[8:11]
  v_and_b32_dpp v16, v62, v26 quad_perm:[2,2,2,2] row_mask:0xf bank_mask:0xf
  v_and_b32_dpp v17, v62, v27 quad_perm:[2,2,2,2] row_mask:0xf bank_mask:0xf
  s_waitcnt vmcnt(4)
  buffer_load_dwordx4 v[124:127], v2, s[44:47], s7 offen offset:768 nt
  v_mfma_f32_16x16x16_bf16 v[4:7], v[14:15], v[100:101], v[4:7]
  v_mfma_f32_16x16x16_bf16 v[8:11], v[14:15], v[102:103], v[8:11]
  v_and_b32_dpp v18, v63, v26 quad_perm:[2,2,2,2] row_mask:0xf bank_mask:0xf
  v_and_b32_dpp v19, v63, v27 quad_perm:[2,2,2,2] row_mask:0xf bank_mask:0xf
  v_mfma_f32_16x16x16_bf16 v[4:7], v[16:17], v[104:105], v[4:7]
  v_mfma_f32_16x16x16_bf16 v[8:11], v[16:17], v[106:107], v[8:11]
  v_and_b32_dpp v12, v60, v26 quad_perm:[3,3,3,3] row_mask:0xf bank_mask:0xf
  v_and_b32_dpp v13, v60, v27 quad_perm:[3,3,3,3] row_mask:0xf bank_mask:0xf
  s_waitcnt vmcnt(4)
  v_mfma_f32_16x16x16_bf16 v[4:7], v[18:19], v[108:109], v[4:7]
  v_mfma_f32_16x16x16_bf16 v[8:11], v[18:19], v[110:111], v[8:11]
  v_and_b32_dpp v14, v61, v26 quad_perm:[3,3,3,3] row_mask:0xf bank_mask:0xf
  v_and_b32_dpp v15, v61, v27 quad_perm:[3,3,3,3] row_mask:0xf bank_mask:0xf
  s_waitcnt vmcnt(3)
  v_mfma_f32_16x16x16_bf16 v[4:7], v[12:13], v[112:113], v[4:7]
  v_mfma_f32_16x16x16_bf16 v[8:11], v[12:13], v[114:115], v[8:11]
  v_and_b32_dpp v16, v62, v26 quad_perm:[3,3,3,3] row_mask:0xf bank_mask:0xf
  v_and_b32_dpp v17, v62, v27 quad_perm:[3,3,3,3] row_mask:0xf bank_mask:0xf
  s_waitcnt vmcnt(2)
  v_mfma_f32_16x16x16_bf16 v[4:7], v[14:15], v[116:117], v[4:7]
  v_mfma_f32_16x16x16_bf16 v[8:11], v[14:15], v[118:119], v[8:11]
  v_and_b32_dpp v18, v63, v26 quad_perm:[3,3,3,3] row_mask:0xf bank_mask:0xf
  v_and_b32_dpp v19, v63, v27 quad_perm:[3,3,3,3] row_mask:0xf bank_mask:0xf
  s_waitcnt vmcnt(1)
  v_mfma_f32_16x16x16_bf16 v[4:7], v[16:17], v[120:121], v[4:7]
  v_mfma_f32_16x16x16_bf16 v[8:11], v[16:17], v[122:123], v[8:11]
  s_waitcnt vmcnt(0)
  v_mfma_f32_16x16x16_bf16 v[4:7], v[18:19], v[124:125], v[4:7]
  v_mfma_f32_16x16x16_bf16 v[8:11], v[18:19], v[126:127], v[8:11]
  s_nop 6
  ds_write_b128 v36, v[4:7] offset:1024
  ds_write_b128 v36, v[8:11] offset:2048
  s_mov_b64 exec, 1
  ds_add_rtn_u32 v31, v37, v38 offset:9988
  s_mov_b64 exec, -1
  ds_read_b128 v[40:43], v34 offset:9216
  ds_read_b128 v[44:47], v34 offset:9232
  ds_read_b128 v[64:67], v35 offset:1024
  ds_read_b128 v[68:71], v35 offset:2048
  ds_read_b128 v[72:75], v35 offset:3072
  ds_read_b128 v[76:79], v35 offset:4096
  ds_read_b128 v[80:83], v35 offset:5120
  ds_read_b128 v[84:87], v35 offset:6144
  ds_read_b128 v[88:91], v35 offset:7168
  ds_read_b128 v[92:95], v35 offset:8192
  v_mov_b32 v14, s39
  s_waitcnt lgkmcnt(10)
  v_readfirstlane_b32 s10, v31
  s_cmp_lg_u32 s10, 3
  s_cbranch_scc1 L_send
  s_waitcnt lgkmcnt(8)
  v_min3_f32 v12, v40, v42, v44
  v_min_f32 v12, v12, v46
  v_sub_f32 v16, v12, v40
  v_sub_f32 v18, v12, v42
  v_sub_f32 v20, v12, v44
  v_sub_f32 v22, v12, v46
  v_exp_f32 v16, v16
  v_exp_f32 v18, v18
  v_exp_f32 v20, v20
  v_exp_f32 v22, v22
  v_mul_f32 v13, v16, v41
  v_fmac_f32 v13, v18, v43
  v_fmac_f32 v13, v20, v45
  v_fmac_f32 v13, v22, v47
  s_waitcnt lgkmcnt(6)
  v_pk_mul_f32 v[48:49], v[64:65], v[16:17] op_sel_hi:[1,0]
  v_pk_mul_f32 v[50:51], v[66:67], v[16:17] op_sel_hi:[1,0]
  v_pk_mul_f32 v[52:53], v[68:69], v[16:17] op_sel_hi:[1,0]
  v_pk_mul_f32 v[54:55], v[70:71], v[16:17] op_sel_hi:[1,0]
  s_waitcnt lgkmcnt(4)
  v_pk_fma_f32 v[48:49], v[72:73], v[18:19], v[48:49] op_sel_hi:[1,0,1]
  v_pk_fma_f32 v[50:51], v[74:75], v[18:19], v[50:51] op_sel_hi:[1,0,1]
  v_pk_fma_f32 v[52:53], v[76:77], v[18:19], v[52:53] op_sel_hi:[1,0,1]
  v_pk_fma_f32 v[54:55], v[78:79], v[18:19], v[54:55] op_sel_hi:[1,0,1]
  s_waitcnt lgkmcnt(2)
  v_pk_fma_f32 v[48:49], v[80:81], v[20:21], v[48:49] op_sel_hi:[1,0,1]
  v_pk_fma_f32 v[50:51], v[82:83], v[20:21], v[50:51] op_sel_hi:[1,0,1]
  v_pk_fma_f32 v[52:53], v[84:85], v[20:21], v[52:53] op_sel_hi:[1,0,1]
  v_pk_fma_f32 v[54:55], v[86:87], v[20:21], v[54:55] op_sel_hi:[1,0,1]
  s_waitcnt lgkmcnt(0)
  v_pk_fma_f32 v[48:49], v[88:89], v[22:23], v[48:49] op_sel_hi:[1,0,1]
  v_pk_fma_f32 v[50:51], v[90:91], v[22:23], v[50:51] op_sel_hi:[1,0,1]
  v_pk_fma_f32 v[52:53], v[92:93], v[22:23], v[52:53] op_sel_hi:[1,0,1]
  v_pk_fma_f32 v[54:55], v[94:95], v[22:23], v[54:55] op_sel_hi:[1,0,1]
  v_bfi_b32 v48, v39, s39, v48
  v_bfi_b32 v49, v39, s81, v49
  v_bfi_b32 v50, v39, s82, v50
  v_bfi_b32 v51, v39, s83, v51
  global_store_dwordx4 v32, v[48:51], s[36:37] sc1
  v_bfi_b32 v52, v39, s39, v52
  v_bfi_b32 v53, v39, s81, v53
  v_bfi_b32 v54, v39, s82, v54
  v_bfi_b32 v55, v39, s83, v55
  global_store_dwordx4 v32, v[52:55], s[36:37] offset:128 sc1
  s_mov_b32 exec_lo, 0x00010001
  s_mov_b32 exec_hi, 0x00010001
  global_store_dwordx4 v33, v[12:15], s[36:37] sc1
L_send:
s_endpgm
.section .rodata,"a"
.p2align 6
.amdhsa_kernel recurrent_scan__gqa_block_cached__dense_activation_relu__decode_kernel
  .amdhsa_next_free_vgpr 256
  .amdhsa_next_free_sgpr 102
  .amdhsa_accum_offset 256
  .amdhsa_group_segment_fixed_size 0
  .amdhsa_kernarg_size 88
  .amdhsa_user_sgpr_count 2
  .amdhsa_user_sgpr_kernarg_segment_ptr 1
  .amdhsa_system_sgpr_workgroup_id_x 1
.end_amdhsa_kernel
```
